```python
import torch

def _softmax(x, axis=-1):
    return torch.softmax(x, dim=axis)
def _gelu(x):
    return torch.nn.functional.gelu(x, approximate="tanh")
def _silu(x):
    return torch.nn.functional.silu(x)
def _sigmoid(x):
    return torch.sigmoid(x)
def _layernorm(x, axis=-1, eps=1e-5):
    m = x.mean(dim=axis, keepdim=True)
    v = x.var(dim=axis, keepdim=True, unbiased=False)
    return (x - m) / torch.sqrt(v + eps)
def _scatter_add(tgt, idx, src, axis=0):
    return tgt.clone().index_add_(axis, idx, src)
def _segment_sum(src, seg, n):
    out = torch.zeros((n,) + src.shape[1:], dtype=src.dtype)
    return out.index_add_(0, seg, src)
def _pad(x, pw):
    flat = tuple(v for pair in reversed(pw) for v in pair)
    return torch.nn.functional.pad(x, flat)

kernel_name = 'standalone__dense_activation_relu__prompt'

def setup_inputs():

    _w = (lambda a: (lambda t: t.to(torch.bfloat16) if t.is_floating_point() else t)(torch.as_tensor(a)))
    B, S, D, Dff = 1, 2048, 640, 1536
    return {
        "x": _w((lambda *s: torch.randn(*s, dtype=torch.bfloat16) * 0.05)(B, S, D)),
        "w1": _w((lambda *s: torch.randn(*s, dtype=torch.bfloat16) * 0.05)(D, Dff)),
        "w2": _w((lambda *s: torch.randn(*s, dtype=torch.bfloat16) * 0.05)(Dff, D)),
    }

def reference(x, w1, w2):
    h = torch.einsum("bsd,df->bsf", x, w1)
    zero = torch.zeros_like(h)
    h = torch.maximum(h, zero)
    return torch.einsum("bsf,fd->bsd", h, w2)
```

```asm
; @launch grid=(256,1,1) block=(256,1,1) lds=139264
.amdgcn_target "amdgcn-amd-amdhsa--gfx950"
.text
.globl standalone__dense_activation_relu__prompt_kernel
.p2align 8
.type standalone__dense_activation_relu__prompt_kernel,@function
standalone__dense_activation_relu__prompt_kernel:
    s_cmp_ge_u32 s2, 256
    s_cbranch_scc1 Lend
    s_load_dwordx4 s[4:7], s[0:1], 0
    s_load_dwordx4 s[8:11], s[0:1], 16
    s_load_dwordx4 s[12:15], s[0:1], 32
    s_memrealtime s[100:101]
    v_lshrrev_b32 v22, 6, v0
    v_and_b32 v1, 63, v0
    s_and_b32 s49, s2, 7
    v_readfirstlane_b32 s44, v22
    s_lshr_b32 s50, s2, 3
    s_lshr_b32 s28, s49, 1
    s_lshl_b32 s28, s28, 3
    s_lshr_b32 s51, s50, 2
    s_add_u32 s28, s28, s51
    s_and_b32 s29, s49, 1
    s_lshl_b32 s29, s29, 2
    s_and_b32 s51, s50, 3
    s_add_u32 s29, s29, s51
    s_lshr_b32 s58, s28, 3
    s_mul_i32 s51, s58, 86
    s_lshr_b32 s51, s51, 8
    s_mul_i32 s51, s51, 3
    s_sub_u32 s58, s58, s51
    s_lshl_b32 s48, s29, 1
    s_add_u32 s48, s48, s28
    s_and_b32 s48, s48, 7
    s_mul_i32 s48, s48, 10
    s_lshr_b32 s48, s48, 3
    s_mul_i32 s46, s28, 81920
    s_mul_i32 s3, s29, 384
    s_mov_b32 s54, s58
    s_lshl_b32 s51, s58, 7
    s_add_u32 s3, s3, s51
    s_lshl_b32 s52, s44, 11
    v_lshrrev_b32 v22, 3, v1
    s_lshl_b32 s51, s44, 4
    v_add_u32 v22, s51, v22
    v_mul_u32_u24 v6, 1280, v22
    v_mul_u32_u24 v5, 3072, v22
    v_and_b32 v23, 7, v1
    v_lshrrev_b32 v24, 4, v1
    v_xor_b32 v22, v23, v24
    v_lshl_add_u32 v2, v22, 4, v6
    v_xor_b32 v22, 4, v22
    v_lshl_add_u32 v3, v22, 4, v6
    v_add_u32 v3, 9216, v3
    v_lshl_add_u32 v6, v23, 4, v6
    v_and_b32 v24, 1, v24
    v_lshlrev_b32 v24, 2, v24
    v_xor_b32 v23, v23, v24
    v_add_u32 v5, s3, v5
    v_lshl_add_u32 v4, v23, 4, v5
    v_add_u32 v5, 23552, v4
    s_mov_b32 s18, 2621440
    s_mov_b32 s19, 0x00020000
    s_mov_b32 s38, 1966080
    s_mov_b32 s39, 0x00020000
    s_mov_b32 s22, 1966080
    s_mov_b32 s23, 0x00020000
    s_mov_b32 s26, 256
    s_mov_b32 s27, 0x00020000
    s_lshl_b32 s47, s28, 3
    s_add_u32 s47, s47, s29
    s_sub_u32 s53, s47, 16
    s_cmp_lt_u32 s47, 240
    s_cselect_b32 s53, s47, s53
    s_mul_i32 s57, s53, 2731
    s_lshr_b32 s57, s57, 16
    s_mul_i32 s51, s57, 24
    s_sub_u32 s53, s53, s51
    s_mul_i32 s51, s53, 81920
    s_lshl_b32 s56, s57, 7
    s_add_u32 s56, s56, s51
    s_waitcnt lgkmcnt(0)
    s_mov_b64 s[16:17], s[4:5]
    s_mov_b64 s[36:37], s[6:7]
    s_mov_b64 s[20:21], s[8:9]
    s_mov_b64 s[24:25], s[12:13]
    s_or_b32 s51, s2, s44
    s_cbranch_scc1 Lnn
    s_bitset1_b32 s101, 31
    v_mov_b32 v36, s100
    v_mov_b32 v37, s101
    s_mov_b64 exec, 1
    buffer_store_dwordx2 v[36:37], off, s[24:27], 0 sc1
    s_mov_b64 exec, -1
Lnn:
    s_lshl_b32 s0, s48, 7
    s_add_u32 m0, s52, 0
    s_add_u32 s0, s0, s46
    buffer_load_dwordx4 v2, s[16:19], s0 offen lds
    s_mul_i32 s60, s48, 196608
    buffer_load_dwordx4 v3, s[16:19], s0 offen offset:1024 lds
    s_add_u32 s48, s48, 1
    s_cmp_eq_u32 s48, 10
    s_cselect_b32 s48, 0, s48
    s_add_u32 m0, s52, 8192
    s_nop 0
    buffer_load_dwordx4 v4, s[36:39], s60 offen lds
    buffer_load_dwordx4 v5, s[36:39], s60 offen offset:1024 lds
    s_lshl_b32 s0, s48, 7
    s_add_u32 m0, s52, 16384
    s_add_u32 s0, s0, s46
    buffer_load_dwordx4 v2, s[16:19], s0 offen lds
    s_mul_i32 s61, s48, 196608
    buffer_load_dwordx4 v3, s[16:19], s0 offen offset:1024 lds
    s_add_u32 s48, s48, 1
    s_cmp_eq_u32 s48, 10
    s_cselect_b32 s48, 0, s48
    s_add_u32 m0, s52, 24576
    s_nop 0
    buffer_load_dwordx4 v4, s[36:39], s61 offen lds
    buffer_load_dwordx4 v5, s[36:39], s61 offen offset:1024 lds
    s_lshl_b32 s0, s48, 7
    s_add_u32 m0, s52, 32768
    s_add_u32 s0, s0, s46
    buffer_load_dwordx4 v2, s[16:19], s0 offen lds
    s_mul_i32 s62, s48, 196608
    buffer_load_dwordx4 v3, s[16:19], s0 offen offset:1024 lds
    s_add_u32 s48, s48, 1
    s_cmp_eq_u32 s48, 10
    s_cselect_b32 s48, 0, s48
    s_add_u32 m0, s52, 40960
    s_nop 0
    buffer_load_dwordx4 v4, s[36:39], s62 offen lds
    buffer_load_dwordx4 v5, s[36:39], s62 offen offset:1024 lds
    s_mov_b64 s[40:41], s[10:11]
    s_mov_b32 s42, 2621440
    s_mov_b32 s43, 0x00020000
    s_mov_b64 s[32:33], s[14:15]
    s_mov_b32 s34, 268435456
    s_mov_b32 s35, 0x00020000
    s_lshr_b32 s30, s49, 1
    s_lshl_b32 s30, s30, 3
    s_lshr_b32 s51, s50, 2
    s_add_u32 s30, s30, s51
    s_and_b32 s31, s49, 1
    s_lshl_b32 s31, s31, 2
    s_and_b32 s51, s50, 3
    s_add_u32 s31, s31, s51
    s_add_u32 m0, s52, 131072
    s_add_u32 s51, s56, 9216
    buffer_load_dwordx4 v6, s[20:23], s56 offen lds
    buffer_load_dwordx4 v6, s[20:23], s51 offen offset:1024 lds
    s_mov_b32 s49, s53
    s_mov_b32 s50, s57
    s_mov_b32 s3, s47
    s_mul_i32 s51, s49, 43
    s_lshr_b32 s51, s51, 8
    s_lshl_b32 s45, s50, 2
    s_add_u32 s45, s45, s51
    s_lshl_b32 s45, s45, 5
    s_mul_i32 s51, s51, 6
    s_sub_u32 s51, s49, s51
    s_add_u32 s45, s45, s51
    s_lshl_b32 s45, s45, 2
    s_sub_u32 s51, s3, 200
    s_lshl_b32 s51, s51, 7
    s_cmp_lt_u32 s3, 240
    s_cselect_b32 s45, s45, s51
    s_add_u32 s45, s45, 10354688
    s_lshl_b32 s50, s50, 2
    s_add_u32 s50, s50, s44
    s_mul_i32 s51, s50, 52
    s_lshr_b32 s51, s51, 8
    s_mul_i32 s56, s51, 235
    s_add_u32 s56, s56, s50
    s_mul_i32 s51, s49, 10
    s_add_u32 s56, s56, s51
    s_lshl_b32 s56, s56, 10
    s_add_u32 s56, s56, 8388608
    s_lshr_b32 s47, s3, 1
    s_lshl_b32 s47, s47, 7
    s_and_b32 s51, s29, 1
    s_lshl_b32 s51, s51, 3
    s_add_u32 s47, s47, s51
    s_add_u32 s47, s47, 10362880
    v_lshlrev_b32 v7, 4, v1
    s_lshl_b32 s59, s30, 2
    s_add_u32 s59, s59, s44
    s_mul_i32 s59, s59, 20480
    s_mul_i32 s51, s31, 160
    s_add_u32 s59, s59, s51
    s_and_b32 s49, s44, 1
    s_lshr_b32 s50, s44, 1
    v_and_b32 v22, 31, v1
    s_lshl_b32 s51, s49, 5
    v_add_u32 v22, s51, v22
    v_lshlrev_b32 v22, 7, v22
    v_bfe_u32 v23, v1, 1, 3
    v_lshrrev_b32 v24, 5, v1
    v_xor_b32 v23, v23, v24
    v_lshl_add_u32 v8, v23, 4, v22
    v_xor_b32 v9, 32, v8
    v_xor_b32 v10, 64, v8
    v_xor_b32 v11, 96, v8
    v_add_u32 v12, 0x10000, v8
    v_add_u32 v13, 0x10000, v9
    v_add_u32 v14, 0x10000, v10
    v_add_u32 v15, 0x10000, v11
    v_lshrrev_b32 v22, 5, v1
    v_lshlrev_b32 v22, 3, v22
    v_bfe_u32 v23, v1, 2, 2
    v_add_u32 v22, v22, v23
    v_lshlrev_b32 v22, 7, v22
    v_bfe_u32 v23, v1, 4, 1
    v_lshl_add_u32 v22, v23, 5, v22
    v_and_b32 v23, 1, v1
    v_lshl_add_u32 v22, v23, 4, v22
    v_bfe_u32 v23, v1, 1, 1
    v_lshl_add_u32 v22, v23, 3, v22
    v_bfe_u32 v23, v1, 3, 1
    v_xor_b32 v23, s50, v23
    v_lshl_add_u32 v16, v23, 6, v22
    v_add_u32 v17, 0x10000, v16
    v_bfe_u32 v22, v1, 4, 1
    v_mul_u32_u24 v22, 49152, v22
    v_and_b32 v23, 15, v1
    v_lshl_add_u32 v22, v23, 4, v22
    v_lshrrev_b32 v23, 5, v1
    v_lshl_add_u32 v18, v23, 8, v22
    s_lshl_b32 s53, s28, 8
    s_mul_i32 s51, s49, 96
    s_add_u32 s53, s53, s51
    s_mul_i32 s51, s29, 6
    s_add_u32 s53, s53, s51
    s_add_u32 s53, s53, s50
    s_lshl_b32 s53, s53, 10
    v_lshrrev_b32 v22, 4, v1
    v_lshlrev_b32 v22, 3, v22
    v_bfe_u32 v23, v1, 2, 2
    v_add_u32 v22, v22, v23
    v_lshlrev_b32 v22, 7, v22
    v_and_b32 v23, 3, v1
    v_lshl_add_u32 v22, v23, 3, v22
    s_lshl_b32 s51, s44, 5
    s_add_u32 s51, s51, 131072
    v_add_u32 v29, s51, v22
    s_mul_i32 s57, s31, 5
    s_lshr_b32 s57, s57, 2
    s_lshl_b32 s57, s57, 2
    s_add_u32 s57, s57, s44
    s_lshl_b32 s57, s57, 7
    s_add_u32 s57, s57, 10354688
    s_lshl_b32 s1, s30, 2
    s_add_u32 s1, s1, s44
    s_lshl_b32 s1, s1, 7
    s_add_u32 s1, s1, 10362880
    s_add_u32 s49, s44, 1
    s_and_b32 s49, s49, 3
    s_mul_i32 s51, s49, 15360
    s_add_u32 s51, s51, 0
    v_add_u32 v25, s51, v7
    s_lshl_b32 s50, s30, 8
    s_mul_i32 s51, s49, 48
    s_add_u32 s50, s50, s51
    s_mul_i32 s51, s44, 12
    s_add_u32 s50, s50, s51
    s_lshl_b32 s50, s50, 10
    v_add_u32 v32, s50, v7
    s_add_u32 s49, s44, 2
    s_and_b32 s49, s49, 3
    s_mul_i32 s51, s49, 15360
    s_add_u32 s51, s51, 5120
    v_add_u32 v26, s51, v7
    s_lshl_b32 s50, s30, 8
    s_mul_i32 s51, s49, 48
    s_add_u32 s50, s50, s51
    s_mul_i32 s51, s44, 12
    s_add_u32 s50, s50, s51
    s_lshl_b32 s50, s50, 10
    v_add_u32 v33, s50, v7
    s_add_u32 s49, s44, 3
    s_and_b32 s49, s49, 3
    s_mul_i32 s51, s49, 15360
    s_add_u32 s51, s51, 10240
    v_add_u32 v27, s51, v7
    s_lshl_b32 s50, s30, 8
    s_mul_i32 s51, s49, 48
    s_add_u32 s50, s50, s51
    s_mul_i32 s51, s44, 12
    s_add_u32 s50, s50, s51
    s_lshl_b32 s50, s50, 10
    v_add_u32 v34, s50, v7
    s_add_u32 s49, s44, 4
    s_and_b32 s49, s49, 3
    s_lshl_b32 s50, s30, 8
    s_mul_i32 s51, s49, 48
    s_add_u32 s50, s50, s51
    s_mul_i32 s51, s44, 12
    s_add_u32 s50, s50, s51
    s_lshl_b32 s50, s50, 10
    v_add_u32 v35, s50, v7
    s_mul_i32 s51, s44, 15360
    v_add_u32 v28, s51, v7
    s_mul_i32 s51, s44, 2816
    s_add_u32 s51, s51, 65536
    v_and_b32 v22, 15, v1
    v_mul_u32_u24 v22, 176, v22
    v_lshrrev_b32 v23, 4, v1
    v_lshl_add_u32 v22, v23, 3, v22
    v_add_u32 v20, s51, v22
    v_add_u32 v22, 0, v1
    v_mul_u32_u24 v23, 205, v22
    v_lshrrev_b32 v23, 11, v23
    v_mul_u32_u24 v24, 10, v23
    v_sub_u32 v22, v22, v24
    v_lshlrev_b32 v22, 4, v22
    v_mul_u32_u24 v24, 1280, v23
    v_add_u32 v38, v24, v22
    v_mul_u32_u24 v24, 176, v23
    v_add3_u32 v42, v24, v22, s51
    v_add_u32 v22, 64, v1
    v_mul_u32_u24 v23, 205, v22
    v_lshrrev_b32 v23, 11, v23
    v_mul_u32_u24 v24, 10, v23
    v_sub_u32 v22, v22, v24
    v_lshlrev_b32 v22, 4, v22
    v_mul_u32_u24 v24, 1280, v23
    v_add_u32 v39, v24, v22
    v_mul_u32_u24 v24, 176, v23
    v_add3_u32 v43, v24, v22, s51
    v_add_u32 v22, 128, v1
    v_mul_u32_u24 v23, 205, v22
    v_lshrrev_b32 v23, 11, v23
    v_mul_u32_u24 v24, 10, v23
    v_sub_u32 v22, v22, v24
    v_lshlrev_b32 v22, 4, v22
    v_mul_u32_u24 v24, 1280, v23
    v_add_u32 v40, v24, v22
    v_mul_u32_u24 v24, 176, v23
    v_add3_u32 v44, v24, v22, s51
    s_lshl_b32 s49, s31, 2
    s_add_u32 s49, s49, s44
    s_mul_i32 s49, s49, 61440
    s_add_u32 s49, s49, 8388608
    v_add_u32 v30, s49, v7
    v_add_u32 v31, 4096, v30
    s_lshr_b32 s49, s30, 3
    s_mul_i32 s51, s49, 86
    s_lshr_b32 s51, s51, 8
    s_mul_i32 s51, s51, 3
    s_sub_u32 s49, s49, s51
    s_mov_b32 s50, s30
    s_add_u32 s51, s50, 0
    s_and_b32 s55, s51, 1
    s_bfe_u32 s51, s51, 0x10001
    s_mul_i32 s51, s51, 6
    s_add_u32 s51, s51, s55
    s_lshl_b32 s4, s51, 10
    s_add_u32 s51, s50, 1
    s_and_b32 s55, s51, 1
    s_bfe_u32 s51, s51, 0x10001
    s_mul_i32 s51, s51, 6
    s_add_u32 s51, s51, s55
    s_lshl_b32 s5, s51, 10
    s_add_u32 s51, s50, 2
    s_and_b32 s55, s51, 1
    s_bfe_u32 s51, s51, 0x10001
    s_mul_i32 s51, s51, 6
    s_add_u32 s51, s51, s55
    s_lshl_b32 s6, s51, 10
    s_add_u32 s51, s50, 3
    s_and_b32 s55, s51, 1
    s_bfe_u32 s51, s51, 0x10001
    s_mul_i32 s51, s51, 6
    s_add_u32 s51, s51, s55
    s_lshl_b32 s7, s51, 10
    s_add_u32 s51, s49, 2
    s_sub_u32 s55, s51, 3
    s_cmp_ge_u32 s51, 3
    s_cselect_b32 s51, s55, s51
    s_lshl_b32 s51, s51, 11
    s_add_u32 s12, s4, s51
    s_add_u32 s13, s5, s51
    s_add_u32 s14, s6, s51
    s_add_u32 s15, s7, s51
    s_add_u32 s51, s49, 1
    s_sub_u32 s55, s51, 3
    s_cmp_ge_u32 s51, 3
    s_cselect_b32 s51, s55, s51
    s_lshl_b32 s51, s51, 11
    s_add_u32 s8, s4, s51
    s_add_u32 s9, s5, s51
    s_add_u32 s10, s6, s51
    s_add_u32 s11, s7, s51
    s_add_u32 s51, s49, 0
    s_sub_u32 s55, s51, 3
    s_cmp_ge_u32 s51, 3
    s_cselect_b32 s51, s55, s51
    s_lshl_b32 s51, s51, 11
    s_add_u32 s4, s4, s51
    s_add_u32 s5, s5, s51
    s_add_u32 s6, s6, s51
    s_add_u32 s7, s7, s51
    s_waitcnt vmcnt(10)
    s_barrier
    ds_read_b128 v[80:83], v8 offset:0
    ds_read_b64_tr_b16 v[224:225], v16 offset:8192
    ds_read_b64_tr_b16 v[226:227], v16 offset:8704
    ds_read_b128 v[84:87], v9 offset:0
    ds_read_b64_tr_b16 v[228:229], v16 offset:10240
    ds_read_b64_tr_b16 v[230:231], v16 offset:10752
    ds_read_b128 v[88:91], v10 offset:0
    ds_read_b64_tr_b16 v[232:233], v16 offset:12288
    ds_read_b64_tr_b16 v[234:235], v16 offset:12800
    s_waitcnt lgkmcnt(6)
    v_mfma_f32_32x32x16_bf16 v[48:63], v[224:227], v[80:83], 0
    ds_read_b128 v[92:95], v11 offset:0
    ds_read_b64_tr_b16 v[236:237], v16 offset:14336
    ds_read_b64_tr_b16 v[238:239], v16 offset:14848
    s_lshl_b32 s0, s48, 7
    s_add_u32 m0, s52, 49152
    s_add_u32 s0, s0, s46
    buffer_load_dwordx4 v2, s[16:19], s0 offen lds
    s_mul_i32 s63, s48, 196608
    buffer_load_dwordx4 v3, s[16:19], s0 offen offset:1024 lds
    s_waitcnt lgkmcnt(6)
    v_mfma_f32_32x32x16_bf16 v[48:63], v[228:231], v[84:87], v[48:63]
    s_waitcnt vmcnt(8)
    s_barrier
    ds_read_b128 v[96:99], v8 offset:16384
    ds_read_b64_tr_b16 v[240:241], v16 offset:24576
    ds_read_b64_tr_b16 v[242:243], v16 offset:25088
    s_add_u32 s48, s48, 1
    s_cmp_eq_u32 s48, 10
    s_cselect_b32 s48, 0, s48
    s_add_u32 m0, s52, 57344
    s_nop 0
    buffer_load_dwordx4 v4, s[36:39], s63 offen lds
    buffer_load_dwordx4 v5, s[36:39], s63 offen offset:1024 lds
    s_waitcnt lgkmcnt(6)
    v_mfma_f32_32x32x16_bf16 v[48:63], v[232:235], v[88:91], v[48:63]
    ds_read_b128 v[100:103], v9 offset:16384
    ds_read_b64_tr_b16 v[244:245], v16 offset:26624
    ds_read_b64_tr_b16 v[246:247], v16 offset:27136
    s_lshl_b32 s0, s48, 7
    s_add_u32 m0, s52, 65536
    s_add_u32 s0, s0, s46
    buffer_load_dwordx4 v2, s[16:19], s0 offen lds
    s_mul_i32 s64, s48, 196608
    buffer_load_dwordx4 v3, s[16:19], s0 offen offset:1024 lds
    s_waitcnt lgkmcnt(6)
    v_mfma_f32_32x32x16_bf16 v[48:63], v[236:239], v[92:95], v[48:63]
    ds_read_b128 v[104:107], v10 offset:16384
    ds_read_b64_tr_b16 v[248:249], v16 offset:28672
    ds_read_b64_tr_b16 v[250:251], v16 offset:29184
    s_add_u32 s48, s48, 1
    s_cmp_eq_u32 s48, 10
    s_cselect_b32 s48, 0, s48
    s_add_u32 m0, s52, 73728
    s_nop 0
    buffer_load_dwordx4 v4, s[36:39], s64 offen lds
    buffer_load_dwordx4 v5, s[36:39], s64 offen offset:1024 lds
    s_waitcnt lgkmcnt(6)
    v_mfma_f32_32x32x16_bf16 v[48:63], v[240:243], v[96:99], v[48:63]
    ds_read_b128 v[108:111], v11 offset:16384
    ds_read_b64_tr_b16 v[252:253], v16 offset:30720
    ds_read_b64_tr_b16 v[254:255], v16 offset:31232
    s_lshl_b32 s0, s48, 7
    s_add_u32 m0, s52, 81920
    s_add_u32 s0, s0, s46
    buffer_load_dwordx4 v2, s[16:19], s0 offen lds
    s_waitcnt lgkmcnt(6)
    v_mfma_f32_32x32x16_bf16 v[48:63], v[244:247], v[100:103], v[48:63]
    s_waitcnt vmcnt(11)
    s_barrier
    ds_read_b128 v[112:115], v8 offset:32768
    ds_read_b64_tr_b16 v[224:225], v16 offset:40960
    ds_read_b64_tr_b16 v[226:227], v16 offset:41472
    s_mul_i32 s65, s48, 196608
    buffer_load_dwordx4 v3, s[16:19], s0 offen offset:1024 lds
    s_add_u32 s48, s48, 1
    s_cmp_eq_u32 s48, 10
    s_cselect_b32 s48, 0, s48
    s_add_u32 m0, s52, 90112
    s_nop 0
    buffer_load_dwordx4 v4, s[36:39], s65 offen lds
    s_waitcnt lgkmcnt(6)
    v_mfma_f32_32x32x16_bf16 v[48:63], v[248:251], v[104:107], v[48:63]
    ds_read_b128 v[116:119], v9 offset:32768
    ds_read_b64_tr_b16 v[228:229], v16 offset:43008
    ds_read_b64_tr_b16 v[230:231], v16 offset:43520
    buffer_load_dwordx4 v5, s[36:39], s65 offen offset:1024 lds
    s_waitcnt lgkmcnt(6)
    v_mfma_f32_32x32x16_bf16 v[48:63], v[252:255], v[108:111], v[48:63]
    ds_read_b128 v[120:123], v10 offset:32768
    ds_read_b64_tr_b16 v[232:233], v16 offset:45056
    ds_read_b64_tr_b16 v[234:235], v16 offset:45568
    s_lshl_b32 s0, s48, 7
    s_add_u32 m0, s52, 98304
    s_add_u32 s0, s0, s46
    buffer_load_dwordx4 v2, s[16:19], s0 offen lds
    s_waitcnt lgkmcnt(6)
    v_mfma_f32_32x32x16_bf16 v[48:63], v[224:227], v[112:115], v[48:63]
    ds_read_b128 v[124:127], v11 offset:32768
    ds_read_b64_tr_b16 v[236:237], v16 offset:47104
    ds_read_b64_tr_b16 v[238:239], v16 offset:47616
    s_mul_i32 s66, s48, 196608
    buffer_load_dwordx4 v3, s[16:19], s0 offen offset:1024 lds
    s_waitcnt lgkmcnt(6)
    v_mfma_f32_32x32x16_bf16 v[48:63], v[228:231], v[116:119], v[48:63]
    s_waitcnt vmcnt(10)
    s_barrier
    ds_read_b64_tr_b16 v[64:65], v29 offset:0
    ds_read_b64_tr_b16 v[66:67], v29 offset:512
    ds_read_b64_tr_b16 v[68:69], v29 offset:4096
    ds_read_b64_tr_b16 v[70:71], v29 offset:4608
    s_add_u32 s49, s56, 5120
    s_waitcnt lgkmcnt(0)
    buffer_store_dwordx4 v[64:67], v7, s[32:35], s56 offen sc1
    buffer_store_dwordx4 v[68:71], v7, s[32:35], s49 offen sc1
    s_load_dwordx2 s[70:71], s[24:25], 0
    ds_read_b128 v[128:131], v8 offset:49152
    ds_read_b64_tr_b16 v[240:241], v16 offset:57344
    ds_read_b64_tr_b16 v[242:243], v16 offset:57856
    s_add_u32 s48, s48, 1
    s_cmp_eq_u32 s48, 10
    s_cselect_b32 s48, 0, s48
    s_add_u32 m0, s52, 106496
    s_nop 0
    buffer_load_dwordx4 v4, s[36:39], s66 offen lds
    buffer_load_dwordx4 v5, s[36:39], s66 offen offset:1024 lds
    v_mfma_f32_32x32x16_bf16 v[48:63], v[232:235], v[120:123], v[48:63]
    ds_read_b128 v[132:135], v9 offset:49152
    ds_read_b64_tr_b16 v[244:245], v16 offset:59392
    ds_read_b64_tr_b16 v[246:247], v16 offset:59904
    s_lshl_b32 s0, s48, 7
    s_add_u32 m0, s52, 114688
    s_add_u32 s0, s0, s46
    buffer_load_dwordx4 v2, s[16:19], s0 offen lds
    v_mfma_f32_32x32x16_bf16 v[48:63], v[236:239], v[124:127], v[48:63]
    ds_read_b128 v[136:139], v10 offset:49152
    ds_read_b64_tr_b16 v[248:249], v16 offset:61440
    ds_read_b64_tr_b16 v[250:251], v16 offset:61952
    s_mul_i32 s67, s48, 196608
    buffer_load_dwordx4 v3, s[16:19], s0 offen offset:1024 lds
    s_waitcnt lgkmcnt(6)
    v_mfma_f32_32x32x16_bf16 v[48:63], v[240:243], v[128:131], v[48:63]
    ds_read_b128 v[140:143], v11 offset:49152
    ds_read_b64_tr_b16 v[252:253], v16 offset:63488
    ds_read_b64_tr_b16 v[254:255], v16 offset:64000
    s_add_u32 s48, s48, 1
    s_cmp_eq_u32 s48, 10
    s_cselect_b32 s48, 0, s48
    s_add_u32 m0, s52, 122880
    s_nop 0
    buffer_load_dwordx4 v4, s[36:39], s67 offen lds
    s_waitcnt lgkmcnt(6)
    v_mfma_f32_32x32x16_bf16 v[48:63], v[244:247], v[132:135], v[48:63]
    s_waitcnt vmcnt(13)
    s_barrier
    ds_read_b128 v[144:147], v12 offset:0
    ds_read_b64_tr_b16 v[224:225], v17 offset:8192
    ds_read_b64_tr_b16 v[226:227], v17 offset:8704
    buffer_load_dwordx4 v5, s[36:39], s67 offen offset:1024 lds
    s_waitcnt lgkmcnt(6)
    v_mfma_f32_32x32x16_bf16 v[48:63], v[248:251], v[136:139], v[48:63]
    ds_read_b128 v[148:151], v13 offset:0
    ds_read_b64_tr_b16 v[228:229], v17 offset:10240
    ds_read_b64_tr_b16 v[230:231], v17 offset:10752
    s_lshl_b32 s0, s48, 7
    s_add_u32 m0, s52, 0
    s_add_u32 s0, s0, s46
    buffer_load_dwordx4 v2, s[16:19], s0 offen lds
    s_waitcnt lgkmcnt(6)
    v_mfma_f32_32x32x16_bf16 v[48:63], v[252:255], v[140:143], v[48:63]
    ds_read_b128 v[152:155], v14 offset:0
    ds_read_b64_tr_b16 v[232:233], v17 offset:12288
    ds_read_b64_tr_b16 v[234:235], v17 offset:12800
    s_mul_i32 s68, s48, 196608
    buffer_load_dwordx4 v3, s[16:19], s0 offen offset:1024 lds
    s_waitcnt lgkmcnt(6)
    v_mfma_f32_32x32x16_bf16 v[48:63], v[224:227], v[144:147], v[48:63]
    ds_read_b128 v[156:159], v15 offset:0
    ds_read_b64_tr_b16 v[236:237], v17 offset:14336
    ds_read_b64_tr_b16 v[238:239], v17 offset:14848
    s_add_u32 s48, s48, 1
    s_cmp_eq_u32 s48, 10
    s_cselect_b32 s48, 0, s48
    s_add_u32 m0, s52, 8192
    s_nop 0
    buffer_load_dwordx4 v4, s[36:39], s68 offen lds
    s_waitcnt lgkmcnt(6)
    v_mfma_f32_32x32x16_bf16 v[48:63], v[228:231], v[148:151], v[48:63]
    s_waitcnt vmcnt(13)
    s_barrier
    s_waitcnt lgkmcnt(0)
    s_mov_b32 s55, 0
Lnon:
    s_cmp_lg_u32 s71, 0
    s_cbranch_scc1 Lnon_ok
    s_sleep 4
    s_load_dwordx2 s[70:71], s[24:25], 0 glc
    s_waitcnt lgkmcnt(0)
    s_add_u32 s55, s55, 1
    s_cmp_lt_u32 s55, 400000
    s_cbranch_scc1 Lnon
Lnon_ok:
    v_mov_b32 v36, s70
    v_mov_b32 v37, s71
    ds_read_b128 v[160:163], v12 offset:16384
    ds_read_b64_tr_b16 v[240:241], v17 offset:24576
    ds_read_b64_tr_b16 v[242:243], v17 offset:25088
    buffer_load_dwordx4 v5, s[36:39], s68 offen offset:1024 lds
    v_mfma_f32_32x32x16_bf16 v[48:63], v[232:235], v[152:155], v[48:63]
    ds_read_b128 v[164:167], v13 offset:16384
    ds_read_b64_tr_b16 v[244:245], v17 offset:26624
    ds_read_b64_tr_b16 v[246:247], v17 offset:27136
    s_lshl_b32 s0, s48, 7
    s_add_u32 m0, s52, 16384
    s_add_u32 s0, s0, s46
    buffer_load_dwordx4 v2, s[16:19], s0 offen lds
    v_mfma_f32_32x32x16_bf16 v[48:63], v[236:239], v[156:159], v[48:63]
    ds_read_b128 v[168:171], v14 offset:16384
    ds_read_b64_tr_b16 v[248:249], v17 offset:28672
    ds_read_b64_tr_b16 v[250:251], v17 offset:29184
    s_mul_i32 s69, s48, 196608
    buffer_load_dwordx4 v3, s[16:19], s0 offen offset:1024 lds
    s_waitcnt lgkmcnt(6)
    v_mfma_f32_32x32x16_bf16 v[48:63], v[240:243], v[160:163], v[48:63]
    ds_read_b128 v[172:175], v15 offset:16384
    ds_read_b64_tr_b16 v[252:253], v17 offset:30720
    ds_read_b64_tr_b16 v[254:255], v17 offset:31232
    s_add_u32 s48, s48, 1
    s_cmp_eq_u32 s48, 10
    s_cselect_b32 s48, 0, s48
    s_add_u32 m0, s52, 24576
    s_nop 0
    buffer_load_dwordx4 v4, s[36:39], s69 offen lds
    s_waitcnt lgkmcnt(6)
    v_mfma_f32_32x32x16_bf16 v[48:63], v[244:247], v[164:167], v[48:63]
    s_waitcnt vmcnt(11)
    s_barrier
    ds_read_b128 v[176:179], v12 offset:32768
    ds_read_b64_tr_b16 v[224:225], v17 offset:40960
    ds_read_b64_tr_b16 v[226:227], v17 offset:41472
    buffer_load_dwordx4 v5, s[36:39], s69 offen offset:1024 lds
    s_waitcnt lgkmcnt(6)
    v_mfma_f32_32x32x16_bf16 v[48:63], v[248:251], v[168:171], v[48:63]
    ds_read_b128 v[180:183], v13 offset:32768
    ds_read_b64_tr_b16 v[228:229], v17 offset:43008
    ds_read_b64_tr_b16 v[230:231], v17 offset:43520
    s_add_u32 s58, s58, 1
    s_cmp_eq_u32 s58, 3
    s_cselect_b32 s58, 0, s58
    s_cselect_b32 s3, -2, 1
    s_lshl_b32 s3, s3, 7
    v_add_u32 v4, s3, v4
    v_add_u32 v5, s3, v5
    s_add_u32 m0, s52, 32768
    s_nop 0
    buffer_load_dwordx4 v4, s[36:39], s60 offen lds
    s_waitcnt lgkmcnt(6)
    v_mfma_f32_32x32x16_bf16 v[48:63], v[252:255], v[172:175], v[48:63]
    ds_read_b128 v[184:187], v14 offset:32768
    ds_read_b64_tr_b16 v[232:233], v17 offset:45056
    ds_read_b64_tr_b16 v[234:235], v17 offset:45568
    buffer_load_dwordx4 v5, s[36:39], s60 offen offset:1024 lds
    s_waitcnt lgkmcnt(6)
    v_mfma_f32_32x32x16_bf16 v[48:63], v[224:227], v[176:179], v[48:63]
    ds_read_b128 v[188:191], v15 offset:32768
    ds_read_b64_tr_b16 v[236:237], v17 offset:47104
    ds_read_b64_tr_b16 v[238:239], v17 offset:47616
    s_add_u32 m0, s52, 40960
    s_nop 0
    buffer_load_dwordx4 v4, s[36:39], s61 offen lds
    s_waitcnt lgkmcnt(6)
    v_mfma_f32_32x32x16_bf16 v[48:63], v[228:231], v[180:183], v[48:63]
    s_waitcnt vmcnt(11)
    s_barrier
    s_cmp_lg_u32 s44, 0
    s_cbranch_scc1 Lnf1
    s_mov_b64 exec, 1
    buffer_store_dword v36, off, s[32:35], s45 sc1
    s_mov_b64 exec, -1
Lnf1:
    ds_read_b128 v[192:195], v12 offset:49152
    ds_read_b64_tr_b16 v[240:241], v17 offset:57344
    ds_read_b64_tr_b16 v[242:243], v17 offset:57856
    buffer_load_dwordx4 v5, s[36:39], s61 offen offset:1024 lds
    s_waitcnt lgkmcnt(6)
    v_mfma_f32_32x32x16_bf16 v[48:63], v[232:235], v[184:187], v[48:63]
    ds_read_b128 v[196:199], v13 offset:49152
    ds_read_b64_tr_b16 v[244:245], v17 offset:59392
    ds_read_b64_tr_b16 v[246:247], v17 offset:59904
    s_add_u32 m0, s52, 49152
    s_nop 0
    buffer_load_dwordx4 v4, s[36:39], s62 offen lds
    s_waitcnt lgkmcnt(6)
    v_mfma_f32_32x32x16_bf16 v[48:63], v[236:239], v[188:191], v[48:63]
    ds_read_b128 v[200:203], v14 offset:49152
    ds_read_b64_tr_b16 v[248:249], v17 offset:61440
    ds_read_b64_tr_b16 v[250:251], v17 offset:61952
    buffer_load_dwordx4 v5, s[36:39], s62 offen offset:1024 lds
    s_waitcnt lgkmcnt(6)
    v_mfma_f32_32x32x16_bf16 v[48:63], v[240:243], v[192:195], v[48:63]
    ds_read_b128 v[204:207], v15 offset:49152
    ds_read_b64_tr_b16 v[252:253], v17 offset:63488
    ds_read_b64_tr_b16 v[254:255], v17 offset:64000
    s_add_u32 m0, s52, 57344
    s_nop 0
    buffer_load_dwordx4 v4, s[36:39], s63 offen lds
    s_waitcnt lgkmcnt(6)
    v_mfma_f32_32x32x16_bf16 v[48:63], v[244:247], v[196:199], v[48:63]
    s_waitcnt vmcnt(11)
    s_barrier
    ds_read_b128 v[208:211], v8 offset:0
    ds_read_b64_tr_b16 v[224:225], v16 offset:8192
    ds_read_b64_tr_b16 v[226:227], v16 offset:8704
    buffer_load_dwordx4 v5, s[36:39], s63 offen offset:1024 lds
    s_waitcnt lgkmcnt(6)
    v_mfma_f32_32x32x16_bf16 v[48:63], v[248:251], v[200:203], v[48:63]
    ds_read_b128 v[212:215], v9 offset:0
    ds_read_b64_tr_b16 v[228:229], v16 offset:10240
    ds_read_b64_tr_b16 v[230:231], v16 offset:10752
    s_add_u32 m0, s52, 65536
    s_nop 0
    buffer_load_dwordx4 v4, s[36:39], s64 offen lds
    s_waitcnt lgkmcnt(6)
    v_mfma_f32_32x32x16_bf16 v[48:63], v[252:255], v[204:207], v[48:63]
    ds_read_b128 v[216:219], v10 offset:0
    ds_read_b64_tr_b16 v[232:233], v16 offset:12288
    ds_read_b64_tr_b16 v[234:235], v16 offset:12800
    buffer_load_dwordx4 v5, s[36:39], s64 offen offset:1024 lds
    s_waitcnt lgkmcnt(6)
    v_mfma_f32_32x32x16_bf16 v[48:63], v[224:227], v[208:211], v[48:63]
    ds_read_b128 v[220:223], v11 offset:0
    ds_read_b64_tr_b16 v[236:237], v16 offset:14336
    ds_read_b64_tr_b16 v[238:239], v16 offset:14848
    s_add_u32 m0, s52, 73728
    s_nop 0
    buffer_load_dwordx4 v4, s[36:39], s65 offen lds
    s_waitcnt lgkmcnt(6)
    v_mfma_f32_32x32x16_bf16 v[48:63], v[228:231], v[212:215], v[48:63]
    s_waitcnt vmcnt(11)
    s_barrier
    ds_read_b128 a[240:243], v8 offset:16384
    ds_read_b64_tr_b16 v[240:241], v16 offset:24576
    ds_read_b64_tr_b16 v[242:243], v16 offset:25088
    buffer_load_dwordx4 v5, s[36:39], s65 offen offset:1024 lds
    s_waitcnt lgkmcnt(6)
    v_mfma_f32_32x32x16_bf16 v[48:63], v[232:235], v[216:219], v[48:63]
    ds_read_b128 a[244:247], v9 offset:16384
    ds_read_b64_tr_b16 v[244:245], v16 offset:26624
    ds_read_b64_tr_b16 v[246:247], v16 offset:27136
    s_add_u32 m0, s52, 81920
    s_nop 0
    buffer_load_dwordx4 v4, s[36:39], s66 offen lds
    s_waitcnt lgkmcnt(6)
    v_mfma_f32_32x32x16_bf16 v[48:63], v[236:239], v[220:223], v[48:63]
    ds_read_b128 a[248:251], v10 offset:16384
    ds_read_b64_tr_b16 v[248:249], v16 offset:28672
    ds_read_b64_tr_b16 v[250:251], v16 offset:29184
    buffer_load_dwordx4 v5, s[36:39], s66 offen offset:1024 lds
    s_waitcnt lgkmcnt(6)
    v_mfma_f32_32x32x16_bf16 v[48:63], v[240:243], a[240:243], v[48:63]
    ds_read_b128 a[252:255], v11 offset:16384
    ds_read_b64_tr_b16 v[252:253], v16 offset:30720
    ds_read_b64_tr_b16 v[254:255], v16 offset:31232
    s_add_u32 m0, s52, 90112
    s_nop 0
    buffer_load_dwordx4 v4, s[36:39], s67 offen lds
    s_waitcnt lgkmcnt(6)
    v_mfma_f32_32x32x16_bf16 v[48:63], v[244:247], a[244:247], v[48:63]
    s_waitcnt vmcnt(11)
    s_barrier
    ds_read_b64_tr_b16 v[224:225], v16 offset:32768
    ds_read_b64_tr_b16 v[226:227], v16 offset:33280
    buffer_load_dwordx4 v5, s[36:39], s67 offen offset:1024 lds
    s_waitcnt lgkmcnt(5)
    v_mfma_f32_32x32x16_bf16 v[48:63], v[248:251], a[248:251], v[48:63]
    ds_read_b64_tr_b16 v[228:229], v16 offset:34816
    ds_read_b64_tr_b16 v[230:231], v16 offset:35328
    s_add_u32 m0, s52, 98304
    s_nop 0
    buffer_load_dwordx4 v4, s[36:39], s68 offen lds
    s_waitcnt lgkmcnt(4)
    v_mfma_f32_32x32x16_bf16 v[48:63], v[252:255], a[252:255], v[48:63]
    ds_read_b64_tr_b16 v[232:233], v16 offset:36864
    ds_read_b64_tr_b16 v[234:235], v16 offset:37376
    ds_read_b64_tr_b16 v[236:237], v16 offset:38912
    ds_read_b64_tr_b16 v[238:239], v16 offset:39424
    buffer_load_dwordx4 v5, s[36:39], s68 offen offset:1024 lds
    s_waitcnt lgkmcnt(4)
    v_mfma_f32_32x32x16_bf16 v[64:79], v[224:227], v[80:83], 0
    ds_read_b64_tr_b16 v[240:241], v16 offset:40960
    ds_read_b64_tr_b16 v[242:243], v16 offset:41472
    ds_read_b64_tr_b16 v[244:245], v16 offset:43008
    ds_read_b64_tr_b16 v[246:247], v16 offset:43520
    v_mfma_f32_32x32x16_bf16 v[64:79], v[228:231], v[84:87], v[64:79]
    ds_read_b64_tr_b16 v[248:249], v16 offset:45056
    ds_read_b64_tr_b16 v[250:251], v16 offset:45568
    ds_read_b64_tr_b16 v[252:253], v16 offset:47104
    ds_read_b64_tr_b16 v[254:255], v16 offset:47616
    s_add_u32 m0, s52, 106496
    s_nop 0
    buffer_load_dwordx4 v4, s[36:39], s69 offen lds
    s_waitcnt lgkmcnt(8)
    v_mfma_f32_32x32x16_bf16 v[64:79], v[232:235], v[88:91], v[64:79]
    s_waitcnt vmcnt(11)
    s_barrier
    ds_read_b64_tr_b16 v[224:225], v16 offset:49152
    ds_read_b64_tr_b16 v[226:227], v16 offset:49664
    buffer_load_dwordx4 v5, s[36:39], s69 offen offset:1024 lds
    v_mfma_f32_32x32x16_bf16 v[64:79], v[236:239], v[92:95], v[64:79]
    ds_read_b64_tr_b16 v[228:229], v16 offset:51200
    ds_read_b64_tr_b16 v[230:231], v16 offset:51712
    s_add_u32 s58, s58, 1
    s_cmp_eq_u32 s58, 3
    s_cselect_b32 s58, 0, s58
    s_cselect_b32 s3, -2, 1
    s_lshl_b32 s3, s3, 7
    v_add_u32 v4, s3, v4
    v_add_u32 v5, s3, v5
    s_add_u32 m0, s52, 114688
    s_nop 0
    buffer_load_dwordx4 v4, s[36:39], s60 offen lds
    v_cvt_pk_bf16_f32 v48, v48, v49
    v_cvt_pk_bf16_f32 v49, v50, v51
    s_waitcnt lgkmcnt(8)
    v_mfma_f32_32x32x16_bf16 v[64:79], v[240:243], v[96:99], v[64:79]
    ds_read_b64_tr_b16 v[232:233], v16 offset:53248
    ds_read_b64_tr_b16 v[234:235], v16 offset:53760
    v_cvt_pk_bf16_f32 v50, v52, v53
    v_cvt_pk_bf16_f32 v51, v54, v55
    v_mfma_f32_32x32x16_bf16 v[64:79], v[244:247], v[100:103], v[64:79]
    ds_read_b64_tr_b16 v[236:237], v16 offset:55296
    ds_read_b64_tr_b16 v[238:239], v16 offset:55808
    buffer_load_dwordx4 v5, s[36:39], s60 offen offset:1024 lds
    v_cvt_pk_bf16_f32 v52, v56, v57
    v_cvt_pk_bf16_f32 v53, v58, v59
    s_waitcnt lgkmcnt(8)
    v_mfma_f32_32x32x16_bf16 v[64:79], v[248:251], v[104:107], v[64:79]
    ds_read_b64_tr_b16 v[240:241], v16 offset:57344
    ds_read_b64_tr_b16 v[242:243], v16 offset:57856
    v_cvt_pk_bf16_f32 v54, v60, v61
    v_cvt_pk_bf16_f32 v55, v62, v63
    v_mfma_f32_32x32x16_bf16 v[64:79], v[252:255], v[108:111], v[64:79]
    ds_read_b64_tr_b16 v[244:245], v16 offset:59392
    ds_read_b64_tr_b16 v[246:247], v16 offset:59904
    s_add_u32 m0, s52, 122880
    s_nop 0
    buffer_load_dwordx4 v4, s[36:39], s61 offen lds
    v_pk_max_i16 v48, v48, 0
    v_pk_max_i16 v49, v49, 0
    s_waitcnt lgkmcnt(8)
    v_mfma_f32_32x32x16_bf16 v[64:79], v[224:227], v[112:115], v[64:79]
    ds_read_b64_tr_b16 v[248:249], v16 offset:61440
    ds_read_b64_tr_b16 v[250:251], v16 offset:61952
    v_pk_max_i16 v50, v50, 0
    v_pk_max_i16 v51, v51, 0
    v_mfma_f32_32x32x16_bf16 v[64:79], v[228:231], v[116:119], v[64:79]
    ds_read_b64_tr_b16 v[252:253], v16 offset:63488
    ds_read_b64_tr_b16 v[254:255], v16 offset:64000
    buffer_load_dwordx4 v5, s[36:39], s61 offen offset:1024 lds
    v_pk_max_i16 v52, v52, 0
    v_pk_max_i16 v53, v53, 0
    s_waitcnt lgkmcnt(8)
    v_mfma_f32_32x32x16_bf16 v[64:79], v[232:235], v[120:123], v[64:79]
    s_waitcnt vmcnt(12)
    s_barrier
    ds_read_b64_tr_b16 v[224:225], v17 offset:0
    ds_read_b64_tr_b16 v[226:227], v17 offset:512
    v_pk_max_i16 v54, v54, 0
    v_pk_max_i16 v55, v55, 0
    v_mfma_f32_32x32x16_bf16 v[64:79], v[236:239], v[124:127], v[64:79]
    ds_read_b64_tr_b16 v[228:229], v17 offset:2048
    ds_read_b64_tr_b16 v[230:231], v17 offset:2560
    s_add_u32 m0, s52, 0
    s_nop 0
    buffer_load_dwordx4 v4, s[36:39], s62 offen lds
    s_lshl_b32 s50, s54, 11
    s_add_u32 s50, s50, s53
    s_waitcnt lgkmcnt(8)
    v_mfma_f32_32x32x16_bf16 v[64:79], v[240:243], v[128:131], v[64:79]
    ds_read_b64_tr_b16 v[232:233], v17 offset:4096
    ds_read_b64_tr_b16 v[234:235], v17 offset:4608
    buffer_store_dwordx4 v[48:51], v18, s[32:35], s50 offen offset:0 sc1
    buffer_store_dwordx4 v[52:55], v18, s[32:35], s50 offen offset:512 sc1
    v_mfma_f32_32x32x16_bf16 v[64:79], v[244:247], v[132:135], v[64:79]
    ds_read_b64_tr_b16 v[236:237], v17 offset:6144
    ds_read_b64_tr_b16 v[238:239], v17 offset:6656
    buffer_load_dwordx4 v5, s[36:39], s62 offen offset:1024 lds
    s_add_u32 s54, s54, 1
    s_cmp_eq_u32 s54, 3
    s_cselect_b32 s54, 0, s54
    s_waitcnt lgkmcnt(8)
    v_mfma_f32_32x32x16_bf16 v[64:79], v[248:251], v[136:139], v[64:79]
    ds_read_b64_tr_b16 v[240:241], v17 offset:8192
    ds_read_b64_tr_b16 v[242:243], v17 offset:8704
    v_mfma_f32_32x32x16_bf16 v[64:79], v[252:255], v[140:143], v[64:79]
    ds_read_b64_tr_b16 v[244:245], v17 offset:10240
    ds_read_b64_tr_b16 v[246:247], v17 offset:10752
    s_add_u32 m0, s52, 8192
    s_nop 0
    buffer_load_dwordx4 v4, s[36:39], s63 offen lds
    s_waitcnt lgkmcnt(8)
    v_mfma_f32_32x32x16_bf16 v[64:79], v[224:227], v[144:147], v[64:79]
    ds_read_b64_tr_b16 v[248:249], v17 offset:12288
    ds_read_b64_tr_b16 v[250:251], v17 offset:12800
    v_mfma_f32_32x32x16_bf16 v[64:79], v[228:231], v[148:151], v[64:79]
    ds_read_b64_tr_b16 v[252:253], v17 offset:14336
    ds_read_b64_tr_b16 v[254:255], v17 offset:14848
    buffer_load_dwordx4 v5, s[36:39], s63 offen offset:1024 lds
    s_waitcnt lgkmcnt(8)
    v_mfma_f32_32x32x16_bf16 v[64:79], v[232:235], v[152:155], v[64:79]
    s_waitcnt vmcnt(14)
    s_barrier
    ds_read_b64_tr_b16 v[224:225], v17 offset:16384
    ds_read_b64_tr_b16 v[226:227], v17 offset:16896
    v_mfma_f32_32x32x16_bf16 v[64:79], v[236:239], v[156:159], v[64:79]
    ds_read_b64_tr_b16 v[228:229], v17 offset:18432
    ds_read_b64_tr_b16 v[230:231], v17 offset:18944
    s_add_u32 m0, s52, 16384
    s_nop 0
    buffer_load_dwordx4 v4, s[36:39], s64 offen lds
    s_waitcnt lgkmcnt(8)
    v_mfma_f32_32x32x16_bf16 v[64:79], v[240:243], v[160:163], v[64:79]
    ds_read_b64_tr_b16 v[232:233], v17 offset:20480
    ds_read_b64_tr_b16 v[234:235], v17 offset:20992
    v_mfma_f32_32x32x16_bf16 v[64:79], v[244:247], v[164:167], v[64:79]
    ds_read_b64_tr_b16 v[236:237], v17 offset:22528
    ds_read_b64_tr_b16 v[238:239], v17 offset:23040
    buffer_load_dwordx4 v5, s[36:39], s64 offen offset:1024 lds
    s_waitcnt lgkmcnt(8)
    v_mfma_f32_32x32x16_bf16 v[64:79], v[248:251], v[168:171], v[64:79]
    ds_read_b64_tr_b16 v[240:241], v17 offset:24576
    ds_read_b64_tr_b16 v[242:243], v17 offset:25088
    v_mfma_f32_32x32x16_bf16 v[64:79], v[252:255], v[172:175], v[64:79]
    ds_read_b64_tr_b16 v[244:245], v17 offset:26624
    ds_read_b64_tr_b16 v[246:247], v17 offset:27136
    s_add_u32 m0, s52, 24576
    s_nop 0
    buffer_load_dwordx4 v4, s[36:39], s65 offen lds
    s_waitcnt lgkmcnt(8)
    v_mfma_f32_32x32x16_bf16 v[64:79], v[224:227], v[176:179], v[64:79]
    ds_read_b64_tr_b16 v[248:249], v17 offset:28672
    ds_read_b64_tr_b16 v[250:251], v17 offset:29184
    v_mfma_f32_32x32x16_bf16 v[64:79], v[228:231], v[180:183], v[64:79]
    ds_read_b64_tr_b16 v[252:253], v17 offset:30720
    ds_read_b64_tr_b16 v[254:255], v17 offset:31232
    buffer_load_dwordx4 v5, s[36:39], s65 offen offset:1024 lds
    s_waitcnt lgkmcnt(8)
    v_mfma_f32_32x32x16_bf16 v[64:79], v[232:235], v[184:187], v[64:79]
    s_waitcnt vmcnt(14)
    s_barrier
    s_load_dwordx8 s[16:23], s[32:33], s57
    s_load_dwordx8 s[24:31], s[32:33], s57 offset:512
    ds_read_b64_tr_b16 v[224:225], v17 offset:32768
    ds_read_b64_tr_b16 v[226:227], v17 offset:33280
    v_mfma_f32_32x32x16_bf16 v[64:79], v[236:239], v[188:191], v[64:79]
    s_add_u32 m0, s52, 32768
    s_nop 0
    buffer_load_dwordx4 v4, s[36:39], s66 offen lds
    s_waitcnt lgkmcnt(6)
    v_mfma_f32_32x32x16_bf16 v[64:79], v[240:243], v[192:195], v[64:79]
    ds_read_b64_tr_b16 v[228:229], v17 offset:34816
    ds_read_b64_tr_b16 v[230:231], v17 offset:35328
    ds_read_b64_tr_b16 v[232:233], v17 offset:36864
    ds_read_b64_tr_b16 v[234:235], v17 offset:37376
    v_mfma_f32_32x32x16_bf16 v[64:79], v[244:247], v[196:199], v[64:79]
    buffer_load_dwordx4 v5, s[36:39], s66 offen offset:1024 lds
    s_waitcnt lgkmcnt(6)
    v_mfma_f32_32x32x16_bf16 v[64:79], v[248:251], v[200:203], v[64:79]
    ds_read_b64_tr_b16 v[236:237], v17 offset:38912
    ds_read_b64_tr_b16 v[238:239], v17 offset:39424
    ds_read_b64_tr_b16 v[240:241], v17 offset:40960
    ds_read_b64_tr_b16 v[242:243], v17 offset:41472
    v_mfma_f32_32x32x16_bf16 v[64:79], v[252:255], v[204:207], v[64:79]
    s_add_u32 m0, s52, 40960
    s_nop 0
    buffer_load_dwordx4 v4, s[36:39], s67 offen lds
    s_waitcnt lgkmcnt(6)
    v_mfma_f32_32x32x16_bf16 v[64:79], v[224:227], v[208:211], v[64:79]
    ds_read_b64_tr_b16 v[244:245], v17 offset:43008
    ds_read_b64_tr_b16 v[246:247], v17 offset:43520
    ds_read_b64_tr_b16 v[248:249], v17 offset:45056
    ds_read_b64_tr_b16 v[250:251], v17 offset:45568
    v_mfma_f32_32x32x16_bf16 v[64:79], v[228:231], v[212:215], v[64:79]
    buffer_load_dwordx4 v5, s[36:39], s67 offen offset:1024 lds
    s_waitcnt lgkmcnt(6)
    v_mfma_f32_32x32x16_bf16 v[64:79], v[232:235], v[216:219], v[64:79]
    ds_read_b64_tr_b16 v[252:253], v17 offset:47104
    ds_read_b64_tr_b16 v[254:255], v17 offset:47616
    s_waitcnt vmcnt(14)
    s_barrier
    ds_read_b64_tr_b16 v[224:225], v17 offset:49152
    ds_read_b64_tr_b16 v[226:227], v17 offset:49664
    v_mfma_f32_32x32x16_bf16 v[64:79], v[236:239], v[220:223], v[64:79]
    s_add_u32 m0, s52, 49152
    s_nop 0
    buffer_load_dwordx4 v4, s[36:39], s68 offen lds
    s_waitcnt lgkmcnt(6)
    v_mfma_f32_32x32x16_bf16 v[64:79], v[240:243], a[240:243], v[64:79]
    ds_read_b64_tr_b16 v[228:229], v17 offset:51200
    ds_read_b64_tr_b16 v[230:231], v17 offset:51712
    ds_read_b64_tr_b16 v[232:233], v17 offset:53248
    ds_read_b64_tr_b16 v[234:235], v17 offset:53760
    v_mfma_f32_32x32x16_bf16 v[64:79], v[244:247], a[244:247], v[64:79]
    buffer_load_dwordx4 v5, s[36:39], s68 offen offset:1024 lds
    s_waitcnt lgkmcnt(6)
    v_mfma_f32_32x32x16_bf16 v[64:79], v[248:251], a[248:251], v[64:79]
    ds_read_b64_tr_b16 v[236:237], v17 offset:55296
    ds_read_b64_tr_b16 v[238:239], v17 offset:55808
    ds_read_b64_tr_b16 v[240:241], v17 offset:57344
    ds_read_b64_tr_b16 v[242:243], v17 offset:57856
    v_mfma_f32_32x32x16_bf16 v[64:79], v[252:255], a[252:255], v[64:79]
    s_add_u32 m0, s52, 57344
    s_nop 0
    buffer_load_dwordx4 v4, s[36:39], s69 offen lds
    s_waitcnt lgkmcnt(6)
    v_mfma_f32_32x32x16_bf16 v[48:63], v[224:227], v[80:83], 0
    ds_read_b64_tr_b16 v[244:245], v17 offset:59392
    ds_read_b64_tr_b16 v[246:247], v17 offset:59904
    ds_read_b64_tr_b16 v[248:249], v17 offset:61440
    ds_read_b64_tr_b16 v[250:251], v17 offset:61952
    v_mfma_f32_32x32x16_bf16 v[48:63], v[228:231], v[84:87], v[48:63]
    buffer_load_dwordx4 v5, s[36:39], s69 offen offset:1024 lds
    s_waitcnt lgkmcnt(6)
    v_mfma_f32_32x32x16_bf16 v[48:63], v[232:235], v[88:91], v[48:63]
    ds_read_b64_tr_b16 v[252:253], v17 offset:63488
    ds_read_b64_tr_b16 v[254:255], v17 offset:64000
    s_waitcnt vmcnt(12)
    s_barrier
    s_waitcnt lgkmcnt(0)
    s_mov_b32 s55, 0
Lpw:
    s_xor_b64 s[16:17], s[16:17], s[18:19]
    s_xor_b64 s[18:19], s[18:19], s[20:21]
    s_xor_b64 s[22:23], s[20:21], s[24:25]
    s_xor_b64 s[24:25], s[24:25], s[26:27]
    s_xor_b64 s[26:27], s[26:27], s[28:29]
    s_xor_b32 s30, s28, s29
    s_xor_b32 s31, s28, s70
    s_or_b64 s[16:17], s[16:17], s[18:19]
    s_or_b64 s[22:23], s[22:23], s[24:25]
    s_or_b64 s[26:27], s[26:27], s[30:31]
    s_or_b64 s[16:17], s[16:17], s[22:23]
    s_or_b64 s[16:17], s[16:17], s[26:27]
    s_cmp_eq_u64 s[16:17], 0
    s_cbranch_scc1 Lpw_ok
    s_sleep 4
    s_load_dwordx8 s[16:23], s[32:33], s57 glc
    s_load_dwordx8 s[24:31], s[32:33], s57 offset:512 glc
    s_waitcnt lgkmcnt(0)
    s_add_u32 s55, s55, 1
    s_cmp_lt_u32 s55, 400000
    s_cbranch_scc1 Lpw
Lpw_ok:
    s_cmp_lg_u32 s44, 0
    s_cbranch_scc1 Lnh0
    s_mov_b64 exec, 1
    buffer_store_dwordx2 v[36:37], off, s[32:35], s47 offset:0 sc1
    s_mov_b64 exec, -1
Lnh0:
    ds_read_b64_tr_b16 v[224:225], v16 offset:0
    ds_read_b64_tr_b16 v[226:227], v16 offset:512
    v_mfma_f32_32x32x16_bf16 v[48:63], v[236:239], v[92:95], v[48:63]
    ds_read_b64_tr_b16 v[228:229], v16 offset:2048
    ds_read_b64_tr_b16 v[230:231], v16 offset:2560
    s_mul_i32 s46, s4, 5
    buffer_load_dwordx4 a[0:3], v30, s[32:35], s46 offen offset:0 sc1
    v_cvt_pk_bf16_f32 v64, v64, v65
    v_cvt_pk_bf16_f32 v65, v66, v67
    v_mfma_f32_32x32x16_bf16 v[48:63], v[240:243], v[96:99], v[48:63]
    ds_read_b64_tr_b16 v[232:233], v16 offset:4096
    ds_read_b64_tr_b16 v[234:235], v16 offset:4608
    v_cvt_pk_bf16_f32 v66, v68, v69
    v_cvt_pk_bf16_f32 v67, v70, v71
    v_mfma_f32_32x32x16_bf16 v[48:63], v[244:247], v[100:103], v[48:63]
    ds_read_b64_tr_b16 v[236:237], v16 offset:6144
    ds_read_b64_tr_b16 v[238:239], v16 offset:6656
    buffer_load_dwordx4 a[4:7], v30, s[32:35], s46 offen offset:1024 sc1
    v_cvt_pk_bf16_f32 v68, v72, v73
    v_cvt_pk_bf16_f32 v69, v74, v75
    v_mfma_f32_32x32x16_bf16 v[48:63], v[248:251], v[104:107], v[48:63]
    ds_read_b64_tr_b16 v[240:241], v16 offset:8192
    ds_read_b64_tr_b16 v[242:243], v16 offset:8704
    v_cvt_pk_bf16_f32 v70, v76, v77
    v_cvt_pk_bf16_f32 v71, v78, v79
    v_mfma_f32_32x32x16_bf16 v[48:63], v[252:255], v[108:111], v[48:63]
    ds_read_b64_tr_b16 v[244:245], v16 offset:10240
    ds_read_b64_tr_b16 v[246:247], v16 offset:10752
    buffer_load_dwordx4 a[8:11], v30, s[32:35], s46 offen offset:2048 sc1
    v_pk_max_i16 v64, v64, 0
    v_pk_max_i16 v65, v65, 0
    s_waitcnt lgkmcnt(8)
    v_mfma_f32_32x32x16_bf16 v[48:63], v[224:227], v[112:115], v[48:63]
    ds_read_b64_tr_b16 v[248:249], v16 offset:12288
    ds_read_b64_tr_b16 v[250:251], v16 offset:12800
    v_pk_max_i16 v66, v66, 0
    v_pk_max_i16 v67, v67, 0
    v_mfma_f32_32x32x16_bf16 v[48:63], v[228:231], v[116:119], v[48:63]
    ds_read_b64_tr_b16 v[252:253], v16 offset:14336
    ds_read_b64_tr_b16 v[254:255], v16 offset:14848
    buffer_load_dwordx4 a[12:15], v30, s[32:35], s46 offen offset:3072 sc1
    v_pk_max_i16 v68, v68, 0
    v_pk_max_i16 v69, v69, 0
    s_waitcnt lgkmcnt(8)
    v_mfma_f32_32x32x16_bf16 v[48:63], v[232:235], v[120:123], v[48:63]
    s_waitcnt vmcnt(12)
    s_barrier
    ds_read_b64_tr_b16 v[224:225], v16 offset:16384
    ds_read_b64_tr_b16 v[226:227], v16 offset:16896
    v_pk_max_i16 v70, v70, 0
    v_pk_max_i16 v71, v71, 0
    v_mfma_f32_32x32x16_bf16 v[48:63], v[236:239], v[124:127], v[48:63]
    ds_read_b64_tr_b16 v[228:229], v16 offset:18432
    ds_read_b64_tr_b16 v[230:231], v16 offset:18944
    buffer_load_dwordx4 a[16:19], v31, s[32:35], s46 offen sc1
    s_lshl_b32 s50, s54, 11
    s_add_u32 s50, s50, s53
    s_waitcnt lgkmcnt(8)
    v_mfma_f32_32x32x16_bf16 v[48:63], v[240:243], v[128:131], v[48:63]
    ds_read_b64_tr_b16 v[232:233], v16 offset:20480
    ds_read_b64_tr_b16 v[234:235], v16 offset:20992
    buffer_store_dwordx4 v[64:67], v18, s[32:35], s50 offen offset:0 sc1
    buffer_store_dwordx4 v[68:71], v18, s[32:35], s50 offen offset:512 sc1
    v_mfma_f32_32x32x16_bf16 v[48:63], v[244:247], v[132:135], v[48:63]
    ds_read_b64_tr_b16 v[236:237], v16 offset:22528
    ds_read_b64_tr_b16 v[238:239], v16 offset:23040
    s_mul_i32 s46, s5, 5
    buffer_load_dwordx4 a[20:23], v30, s[32:35], s46 offen offset:0 sc1
    s_add_u32 s54, s54, 1
    s_cmp_eq_u32 s54, 3
    s_cselect_b32 s54, 0, s54
    s_waitcnt lgkmcnt(8)
    v_mfma_f32_32x32x16_bf16 v[48:63], v[248:251], v[136:139], v[48:63]
    ds_read_b64_tr_b16 v[240:241], v16 offset:24576
    ds_read_b64_tr_b16 v[242:243], v16 offset:25088
    v_mfma_f32_32x32x16_bf16 v[48:63], v[252:255], v[140:143], v[48:63]
    ds_read_b64_tr_b16 v[244:245], v16 offset:26624
    ds_read_b64_tr_b16 v[246:247], v16 offset:27136
    buffer_load_dwordx4 a[24:27], v30, s[32:35], s46 offen offset:1024 sc1
    s_waitcnt lgkmcnt(8)
    v_mfma_f32_32x32x16_bf16 v[48:63], v[224:227], v[144:147], v[48:63]
    ds_read_b64_tr_b16 v[248:249], v16 offset:28672
    ds_read_b64_tr_b16 v[250:251], v16 offset:29184
    v_mfma_f32_32x32x16_bf16 v[48:63], v[228:231], v[148:151], v[48:63]
    ds_read_b64_tr_b16 v[252:253], v16 offset:30720
    ds_read_b64_tr_b16 v[254:255], v16 offset:31232
    buffer_load_dwordx4 a[28:31], v30, s[32:35], s46 offen offset:2048 sc1
    s_waitcnt lgkmcnt(8)
    v_mfma_f32_32x32x16_bf16 v[48:63], v[232:235], v[152:155], v[48:63]
    s_waitcnt vmcnt(14)
    s_barrier
    ds_read_b64_tr_b16 v[224:225], v16 offset:32768
    ds_read_b64_tr_b16 v[226:227], v16 offset:33280
    v_mfma_f32_32x32x16_bf16 v[48:63], v[236:239], v[156:159], v[48:63]
    ds_read_b64_tr_b16 v[228:229], v16 offset:34816
    ds_read_b64_tr_b16 v[230:231], v16 offset:35328
    buffer_load_dwordx4 a[32:35], v30, s[32:35], s46 offen offset:3072 sc1
    s_waitcnt lgkmcnt(8)
    v_mfma_f32_32x32x16_bf16 v[48:63], v[240:243], v[160:163], v[48:63]
    ds_read_b64_tr_b16 v[232:233], v16 offset:36864
    ds_read_b64_tr_b16 v[234:235], v16 offset:37376
    v_mfma_f32_32x32x16_bf16 v[48:63], v[244:247], v[164:167], v[48:63]
    ds_read_b64_tr_b16 v[236:237], v16 offset:38912
    ds_read_b64_tr_b16 v[238:239], v16 offset:39424
    buffer_load_dwordx4 a[36:39], v31, s[32:35], s46 offen sc1
    s_waitcnt lgkmcnt(8)
    v_mfma_f32_32x32x16_bf16 v[48:63], v[248:251], v[168:171], v[48:63]
    ds_read_b64_tr_b16 v[240:241], v16 offset:40960
    ds_read_b64_tr_b16 v[242:243], v16 offset:41472
    v_mfma_f32_32x32x16_bf16 v[48:63], v[252:255], v[172:175], v[48:63]
    ds_read_b64_tr_b16 v[244:245], v16 offset:43008
    ds_read_b64_tr_b16 v[246:247], v16 offset:43520
    s_mul_i32 s46, s6, 5
    buffer_load_dwordx4 a[40:43], v30, s[32:35], s46 offen offset:0 sc1
    s_waitcnt lgkmcnt(8)
    v_mfma_f32_32x32x16_bf16 v[48:63], v[224:227], v[176:179], v[48:63]
    ds_read_b64_tr_b16 v[248:249], v16 offset:45056
    ds_read_b64_tr_b16 v[250:251], v16 offset:45568
    v_mfma_f32_32x32x16_bf16 v[48:63], v[228:231], v[180:183], v[48:63]
    ds_read_b64_tr_b16 v[252:253], v16 offset:47104
    ds_read_b64_tr_b16 v[254:255], v16 offset:47616
    buffer_load_dwordx4 a[44:47], v30, s[32:35], s46 offen offset:1024 sc1
    s_waitcnt lgkmcnt(8)
    v_mfma_f32_32x32x16_bf16 v[48:63], v[232:235], v[184:187], v[48:63]
    s_waitcnt vmcnt(14)
    s_barrier
    ds_read_b64_tr_b16 v[224:225], v16 offset:49152
    ds_read_b64_tr_b16 v[226:227], v16 offset:49664
    v_mfma_f32_32x32x16_bf16 v[48:63], v[236:239], v[188:191], v[48:63]
    ds_read_b64_tr_b16 v[228:229], v16 offset:51200
    ds_read_b64_tr_b16 v[230:231], v16 offset:51712
    buffer_load_dwordx4 a[48:51], v30, s[32:35], s46 offen offset:2048 sc1
    s_waitcnt lgkmcnt(8)
    v_mfma_f32_32x32x16_bf16 v[48:63], v[240:243], v[192:195], v[48:63]
    ds_read_b64_tr_b16 v[232:233], v16 offset:53248
    ds_read_b64_tr_b16 v[234:235], v16 offset:53760
    v_mfma_f32_32x32x16_bf16 v[48:63], v[244:247], v[196:199], v[48:63]
    ds_read_b64_tr_b16 v[236:237], v16 offset:55296
    ds_read_b64_tr_b16 v[238:239], v16 offset:55808
    buffer_load_dwordx4 a[52:55], v30, s[32:35], s46 offen offset:3072 sc1
    s_waitcnt lgkmcnt(8)
    v_mfma_f32_32x32x16_bf16 v[48:63], v[248:251], v[200:203], v[48:63]
    ds_read_b64_tr_b16 v[240:241], v16 offset:57344
    ds_read_b64_tr_b16 v[242:243], v16 offset:57856
    v_mfma_f32_32x32x16_bf16 v[48:63], v[252:255], v[204:207], v[48:63]
    ds_read_b64_tr_b16 v[244:245], v16 offset:59392
    ds_read_b64_tr_b16 v[246:247], v16 offset:59904
    buffer_load_dwordx4 a[56:59], v31, s[32:35], s46 offen sc1
    s_waitcnt lgkmcnt(8)
    v_mfma_f32_32x32x16_bf16 v[48:63], v[224:227], v[208:211], v[48:63]
    ds_read_b64_tr_b16 v[248:249], v16 offset:61440
    ds_read_b64_tr_b16 v[250:251], v16 offset:61952
    v_mfma_f32_32x32x16_bf16 v[48:63], v[228:231], v[212:215], v[48:63]
    ds_read_b64_tr_b16 v[252:253], v16 offset:63488
    ds_read_b64_tr_b16 v[254:255], v16 offset:64000
    s_mul_i32 s46, s7, 5
    buffer_load_dwordx4 a[60:63], v30, s[32:35], s46 offen offset:0 sc1
    s_waitcnt lgkmcnt(8)
    v_mfma_f32_32x32x16_bf16 v[48:63], v[232:235], v[216:219], v[48:63]
    v_mfma_f32_32x32x16_bf16 v[48:63], v[236:239], v[220:223], v[48:63]
    buffer_load_dwordx4 a[64:67], v30, s[32:35], s46 offen offset:1024 sc1
    s_waitcnt lgkmcnt(4)
    v_mfma_f32_32x32x16_bf16 v[48:63], v[240:243], a[240:243], v[48:63]
    v_mfma_f32_32x32x16_bf16 v[48:63], v[244:247], a[244:247], v[48:63]
    buffer_load_dwordx4 a[68:71], v30, s[32:35], s46 offen offset:2048 sc1
    s_waitcnt lgkmcnt(0)
    v_mfma_f32_32x32x16_bf16 v[48:63], v[248:251], a[248:251], v[48:63]
    v_mfma_f32_32x32x16_bf16 v[48:63], v[252:255], a[252:255], v[48:63]
    buffer_load_dwordx4 a[72:75], v30, s[32:35], s46 offen offset:3072 sc1
    s_load_dwordx4 s[16:19], s[32:33], s1 glc
    buffer_load_dwordx4 a[76:79], v31, s[32:35], s46 offen sc1
    s_mul_i32 s46, s8, 5
    buffer_load_dwordx4 a[80:83], v30, s[32:35], s46 offen offset:0 sc1
    buffer_load_dwordx4 a[84:87], v30, s[32:35], s46 offen offset:1024 sc1
    s_nop 7
    s_nop 3
    v_cvt_pk_bf16_f32 v48, v48, v49
    v_cvt_pk_bf16_f32 v49, v50, v51
    v_cvt_pk_bf16_f32 v50, v52, v53
    v_cvt_pk_bf16_f32 v51, v54, v55
    v_cvt_pk_bf16_f32 v52, v56, v57
    v_cvt_pk_bf16_f32 v53, v58, v59
    v_cvt_pk_bf16_f32 v54, v60, v61
    v_cvt_pk_bf16_f32 v55, v62, v63
    v_pk_max_i16 v48, v48, 0
    v_pk_max_i16 v49, v49, 0
    v_pk_max_i16 v50, v50, 0
    v_pk_max_i16 v51, v51, 0
    v_pk_max_i16 v52, v52, 0
    v_pk_max_i16 v53, v53, 0
    v_pk_max_i16 v54, v54, 0
    v_pk_max_i16 v55, v55, 0
    s_lshl_b32 s50, s54, 11
    s_add_u32 s50, s50, s53
    buffer_store_dwordx4 v[48:51], v18, s[32:35], s50 offen offset:0 sc1
    buffer_store_dwordx4 v[52:55], v18, s[32:35], s50 offen offset:512 sc1
    s_add_u32 s54, s54, 1
    s_cmp_eq_u32 s54, 3
    s_cselect_b32 s54, 0, s54
    buffer_load_dwordx4 a[88:91], v30, s[32:35], s46 offen offset:2048 sc1
    buffer_load_dwordx4 a[92:95], v30, s[32:35], s46 offen offset:3072 sc1
    buffer_load_dwordx4 a[96:99], v31, s[32:35], s46 offen sc1
    s_mul_i32 s46, s9, 5
    buffer_load_dwordx4 a[100:103], v30, s[32:35], s46 offen offset:0 sc1
    buffer_load_dwordx4 a[104:107], v30, s[32:35], s46 offen offset:1024 sc1
    buffer_load_dwordx4 a[108:111], v30, s[32:35], s46 offen offset:2048 sc1
    buffer_load_dwordx4 a[112:115], v30, s[32:35], s46 offen offset:3072 sc1
    buffer_load_dwordx4 a[116:119], v31, s[32:35], s46 offen sc1
    s_waitcnt lgkmcnt(0)
    s_mov_b32 s55, 0
Lph0:
    s_xor_b64 s[16:17], s[16:17], s[70:71]
    s_xor_b64 s[18:19], s[18:19], s[70:71]
    s_or_b64 s[16:17], s[16:17], s[18:19]
    s_cmp_eq_u64 s[16:17], 0
    s_cbranch_scc1 Lph0_ok
    s_sleep 4
    s_load_dwordx4 s[16:19], s[32:33], s1 glc
    s_waitcnt lgkmcnt(0)
    s_add_u32 s55, s55, 1
    s_cmp_lt_u32 s55, 400000
    s_cbranch_scc1 Lph0
Lph0_ok:
    buffer_load_dwordx4 v[80:83], v32, s[32:35], s4 offen sc1
    buffer_load_dwordx4 v[84:87], v33, s[32:35], s4 offen sc1
    buffer_load_dwordx4 v[88:91], v34, s[32:35], s4 offen sc1
    buffer_load_dwordx4 v[92:95], v35, s[32:35], s4 offen sc1
    s_waitcnt vmcnt(31)
    s_barrier
    s_cmp_lg_u32 s44, 0
    s_cbranch_scc1 Lnh1
    s_mov_b64 exec, 1
    buffer_store_dwordx2 v[36:37], off, s[32:35], s47 offset:16 sc1
    s_mov_b64 exec, -1
Lnh1:
    s_mul_i32 s46, s10, 5
    buffer_load_dwordx4 a[120:123], v30, s[32:35], s46 offen offset:0 sc1
    buffer_load_dwordx4 a[124:127], v30, s[32:35], s46 offen offset:1024 sc1
    buffer_load_dwordx4 a[128:131], v30, s[32:35], s46 offen offset:2048 sc1
    buffer_load_dwordx4 a[132:135], v30, s[32:35], s46 offen offset:3072 sc1
    buffer_load_dwordx4 a[136:139], v31, s[32:35], s46 offen sc1
    buffer_load_dwordx4 v[96:99], v32, s[32:35], s5 offen sc1
    buffer_load_dwordx4 v[100:103], v33, s[32:35], s5 offen sc1
    buffer_load_dwordx4 v[104:107], v34, s[32:35], s5 offen sc1
    buffer_load_dwordx4 v[108:111], v35, s[32:35], s5 offen sc1
    s_waitcnt vmcnt(12)
    v_mfma_f32_16x16x32_bf16 v[176:179], a[0:3], v[80:83], 0
    v_mfma_f32_16x16x32_bf16 v[180:183], a[4:7], v[80:83], 0
    v_mfma_f32_16x16x32_bf16 v[184:187], a[8:11], v[80:83], 0
    v_mfma_f32_16x16x32_bf16 v[188:191], a[12:15], v[80:83], 0
    v_mfma_f32_16x16x32_bf16 v[192:195], a[16:19], v[80:83], 0
    buffer_load_dwordx4 v[112:115], v32, s[32:35], s6 offen sc1
    s_waitcnt vmcnt(12)
    v_mfma_f32_16x16x32_bf16 v[196:199], a[0:3], v[84:87], 0
    v_mfma_f32_16x16x32_bf16 v[200:203], a[4:7], v[84:87], 0
    v_mfma_f32_16x16x32_bf16 v[204:207], a[8:11], v[84:87], 0
    v_mfma_f32_16x16x32_bf16 v[208:211], a[12:15], v[84:87], 0
    v_mfma_f32_16x16x32_bf16 v[212:215], a[16:19], v[84:87], 0
    buffer_load_dwordx4 v[116:119], v33, s[32:35], s6 offen sc1
    s_waitcnt vmcnt(12)
    v_mfma_f32_16x16x32_bf16 v[216:219], a[0:3], v[88:91], 0
    v_mfma_f32_16x16x32_bf16 v[220:223], a[4:7], v[88:91], 0
    v_mfma_f32_16x16x32_bf16 v[224:227], a[8:11], v[88:91], 0
    v_mfma_f32_16x16x32_bf16 v[228:231], a[12:15], v[88:91], 0
    v_mfma_f32_16x16x32_bf16 v[232:235], a[16:19], v[88:91], 0
    buffer_load_dwordx4 v[120:123], v34, s[32:35], s6 offen sc1
    s_barrier
    s_cmp_lg_u32 s44, 0
    s_cbranch_scc1 Lnh2
    s_mov_b64 exec, 1
    buffer_store_dwordx2 v[36:37], off, s[32:35], s47 offset:32 sc1
    s_mov_b64 exec, -1
Lnh2:
    s_waitcnt vmcnt(12)
    v_mfma_f32_16x16x32_bf16 v[236:239], a[0:3], v[92:95], 0
    v_mfma_f32_16x16x32_bf16 v[240:243], a[4:7], v[92:95], 0
    v_mfma_f32_16x16x32_bf16 v[244:247], a[8:11], v[92:95], 0
    v_mfma_f32_16x16x32_bf16 v[248:251], a[12:15], v[92:95], 0
    v_mfma_f32_16x16x32_bf16 v[252:255], a[16:19], v[92:95], 0
    buffer_load_dwordx4 v[124:127], v35, s[32:35], s6 offen sc1
    s_mul_i32 s46, s11, 5
    buffer_load_dwordx4 a[140:143], v30, s[32:35], s46 offen offset:0 sc1
    s_add_u32 s1, s1, 16
    s_load_dwordx4 s[16:19], s[32:33], s1 glc
    buffer_load_dwordx4 a[144:147], v30, s[32:35], s46 offen offset:1024 sc1
    buffer_load_dwordx4 a[148:151], v30, s[32:35], s46 offen offset:2048 sc1
    buffer_load_dwordx4 a[152:155], v30, s[32:35], s46 offen offset:3072 sc1
    buffer_load_dwordx4 a[156:159], v31, s[32:35], s46 offen sc1
    s_waitcnt vmcnt(12)
    v_mfma_f32_16x16x32_bf16 v[176:179], a[20:23], v[96:99], v[176:179]
    v_mfma_f32_16x16x32_bf16 v[180:183], a[24:27], v[96:99], v[180:183]
    v_mfma_f32_16x16x32_bf16 v[184:187], a[28:31], v[96:99], v[184:187]
    v_mfma_f32_16x16x32_bf16 v[188:191], a[32:35], v[96:99], v[188:191]
    v_mfma_f32_16x16x32_bf16 v[192:195], a[36:39], v[96:99], v[192:195]
    buffer_load_dwordx4 v[128:131], v32, s[32:35], s7 offen sc1
    s_waitcnt vmcnt(12)
    v_mfma_f32_16x16x32_bf16 v[196:199], a[20:23], v[100:103], v[196:199]
    v_mfma_f32_16x16x32_bf16 v[200:203], a[24:27], v[100:103], v[200:203]
    v_mfma_f32_16x16x32_bf16 v[204:207], a[28:31], v[100:103], v[204:207]
    v_mfma_f32_16x16x32_bf16 v[208:211], a[32:35], v[100:103], v[208:211]
    v_mfma_f32_16x16x32_bf16 v[212:215], a[36:39], v[100:103], v[212:215]
    buffer_load_dwordx4 v[132:135], v33, s[32:35], s7 offen sc1
    s_waitcnt vmcnt(12)
    v_mfma_f32_16x16x32_bf16 v[216:219], a[20:23], v[104:107], v[216:219]
    v_mfma_f32_16x16x32_bf16 v[220:223], a[24:27], v[104:107], v[220:223]
    v_mfma_f32_16x16x32_bf16 v[224:227], a[28:31], v[104:107], v[224:227]
    v_mfma_f32_16x16x32_bf16 v[228:231], a[32:35], v[104:107], v[228:231]
    v_mfma_f32_16x16x32_bf16 v[232:235], a[36:39], v[104:107], v[232:235]
    buffer_load_dwordx4 v[136:139], v34, s[32:35], s7 offen sc1
    s_waitcnt vmcnt(12)
    v_mfma_f32_16x16x32_bf16 v[236:239], a[20:23], v[108:111], v[236:239]
    v_mfma_f32_16x16x32_bf16 v[240:243], a[24:27], v[108:111], v[240:243]
    v_mfma_f32_16x16x32_bf16 v[244:247], a[28:31], v[108:111], v[244:247]
    v_mfma_f32_16x16x32_bf16 v[248:251], a[32:35], v[108:111], v[248:251]
    v_mfma_f32_16x16x32_bf16 v[252:255], a[36:39], v[108:111], v[252:255]
    buffer_load_dwordx4 v[140:143], v35, s[32:35], s7 offen sc1
    s_waitcnt vmcnt(12)
    v_mfma_f32_16x16x32_bf16 v[176:179], a[40:43], v[112:115], v[176:179]
    v_mfma_f32_16x16x32_bf16 v[180:183], a[44:47], v[112:115], v[180:183]
    v_mfma_f32_16x16x32_bf16 v[184:187], a[48:51], v[112:115], v[184:187]
    v_mfma_f32_16x16x32_bf16 v[188:191], a[52:55], v[112:115], v[188:191]
    v_mfma_f32_16x16x32_bf16 v[192:195], a[56:59], v[112:115], v[192:195]
    s_waitcnt lgkmcnt(0)
    s_mov_b32 s55, 0
Lph1:
    s_xor_b64 s[16:17], s[16:17], s[70:71]
    s_xor_b64 s[18:19], s[18:19], s[70:71]
    s_or_b64 s[16:17], s[16:17], s[18:19]
    s_cmp_eq_u64 s[16:17], 0
    s_cbranch_scc1 Lph1_ok
    s_sleep 4
    s_load_dwordx4 s[16:19], s[32:33], s1 glc
    s_waitcnt lgkmcnt(0)
    s_add_u32 s55, s55, 1
    s_cmp_lt_u32 s55, 400000
    s_cbranch_scc1 Lph1
Lph1_ok:
    buffer_load_dwordx4 v[144:147], v32, s[32:35], s8 offen sc1
    s_waitcnt vmcnt(12)
    v_mfma_f32_16x16x32_bf16 v[196:199], a[40:43], v[116:119], v[196:199]
    v_mfma_f32_16x16x32_bf16 v[200:203], a[44:47], v[116:119], v[200:203]
    v_mfma_f32_16x16x32_bf16 v[204:207], a[48:51], v[116:119], v[204:207]
    v_mfma_f32_16x16x32_bf16 v[208:211], a[52:55], v[116:119], v[208:211]
    v_mfma_f32_16x16x32_bf16 v[212:215], a[56:59], v[116:119], v[212:215]
    buffer_load_dwordx4 v[148:151], v33, s[32:35], s8 offen sc1
    s_waitcnt vmcnt(12)
    v_mfma_f32_16x16x32_bf16 v[216:219], a[40:43], v[120:123], v[216:219]
    v_mfma_f32_16x16x32_bf16 v[220:223], a[44:47], v[120:123], v[220:223]
    v_mfma_f32_16x16x32_bf16 v[224:227], a[48:51], v[120:123], v[224:227]
    v_mfma_f32_16x16x32_bf16 v[228:231], a[52:55], v[120:123], v[228:231]
    v_mfma_f32_16x16x32_bf16 v[232:235], a[56:59], v[120:123], v[232:235]
    buffer_load_dwordx4 v[152:155], v34, s[32:35], s8 offen sc1
    s_waitcnt vmcnt(12)
    v_mfma_f32_16x16x32_bf16 v[236:239], a[40:43], v[124:127], v[236:239]
    v_mfma_f32_16x16x32_bf16 v[240:243], a[44:47], v[124:127], v[240:243]
    v_mfma_f32_16x16x32_bf16 v[244:247], a[48:51], v[124:127], v[244:247]
    v_mfma_f32_16x16x32_bf16 v[248:251], a[52:55], v[124:127], v[248:251]
    v_mfma_f32_16x16x32_bf16 v[252:255], a[56:59], v[124:127], v[252:255]
    buffer_load_dwordx4 v[156:159], v35, s[32:35], s8 offen sc1
    s_mul_i32 s46, s12, 5
    buffer_load_dwordx4 a[160:163], v30, s[32:35], s46 offen offset:0 sc1
    buffer_load_dwordx4 a[164:167], v30, s[32:35], s46 offen offset:1024 sc1
    buffer_load_dwordx4 a[168:171], v30, s[32:35], s46 offen offset:2048 sc1
    buffer_load_dwordx4 a[172:175], v30, s[32:35], s46 offen offset:3072 sc1
    buffer_load_dwordx4 a[176:179], v31, s[32:35], s46 offen sc1
    s_waitcnt vmcnt(12)
    v_mfma_f32_16x16x32_bf16 v[176:179], a[60:63], v[128:131], v[176:179]
    v_mfma_f32_16x16x32_bf16 v[180:183], a[64:67], v[128:131], v[180:183]
    v_mfma_f32_16x16x32_bf16 v[184:187], a[68:71], v[128:131], v[184:187]
    v_mfma_f32_16x16x32_bf16 v[188:191], a[72:75], v[128:131], v[188:191]
    v_mfma_f32_16x16x32_bf16 v[192:195], a[76:79], v[128:131], v[192:195]
    buffer_load_dwordx4 v[160:163], v32, s[32:35], s9 offen sc1
    s_waitcnt vmcnt(12)
    v_mfma_f32_16x16x32_bf16 v[196:199], a[60:63], v[132:135], v[196:199]
    v_mfma_f32_16x16x32_bf16 v[200:203], a[64:67], v[132:135], v[200:203]
    v_mfma_f32_16x16x32_bf16 v[204:207], a[68:71], v[132:135], v[204:207]
    v_mfma_f32_16x16x32_bf16 v[208:211], a[72:75], v[132:135], v[208:211]
    v_mfma_f32_16x16x32_bf16 v[212:215], a[76:79], v[132:135], v[212:215]
    buffer_load_dwordx4 v[164:167], v33, s[32:35], s9 offen sc1
    s_waitcnt vmcnt(12)
    v_mfma_f32_16x16x32_bf16 v[216:219], a[60:63], v[136:139], v[216:219]
    v_mfma_f32_16x16x32_bf16 v[220:223], a[64:67], v[136:139], v[220:223]
    v_mfma_f32_16x16x32_bf16 v[224:227], a[68:71], v[136:139], v[224:227]
    v_mfma_f32_16x16x32_bf16 v[228:231], a[72:75], v[136:139], v[228:231]
    v_mfma_f32_16x16x32_bf16 v[232:235], a[76:79], v[136:139], v[232:235]
    buffer_load_dwordx4 v[168:171], v34, s[32:35], s9 offen sc1
    s_waitcnt vmcnt(12)
    v_mfma_f32_16x16x32_bf16 v[236:239], a[60:63], v[140:143], v[236:239]
    v_mfma_f32_16x16x32_bf16 v[240:243], a[64:67], v[140:143], v[240:243]
    v_mfma_f32_16x16x32_bf16 v[244:247], a[68:71], v[140:143], v[244:247]
    v_mfma_f32_16x16x32_bf16 v[248:251], a[72:75], v[140:143], v[248:251]
    v_mfma_f32_16x16x32_bf16 v[252:255], a[76:79], v[140:143], v[252:255]
    buffer_load_dwordx4 v[172:175], v35, s[32:35], s9 offen sc1
    s_waitcnt vmcnt(12)
    v_mfma_f32_16x16x32_bf16 v[176:179], a[80:83], v[144:147], v[176:179]
    v_mfma_f32_16x16x32_bf16 v[180:183], a[84:87], v[144:147], v[180:183]
    v_mfma_f32_16x16x32_bf16 v[184:187], a[88:91], v[144:147], v[184:187]
    v_mfma_f32_16x16x32_bf16 v[188:191], a[92:95], v[144:147], v[188:191]
    v_mfma_f32_16x16x32_bf16 v[192:195], a[96:99], v[144:147], v[192:195]
    buffer_load_dwordx4 v[80:83], v32, s[32:35], s10 offen sc1
    s_waitcnt vmcnt(12)
    v_mfma_f32_16x16x32_bf16 v[196:199], a[80:83], v[148:151], v[196:199]
    v_mfma_f32_16x16x32_bf16 v[200:203], a[84:87], v[148:151], v[200:203]
    v_mfma_f32_16x16x32_bf16 v[204:207], a[88:91], v[148:151], v[204:207]
    v_mfma_f32_16x16x32_bf16 v[208:211], a[92:95], v[148:151], v[208:211]
    v_mfma_f32_16x16x32_bf16 v[212:215], a[96:99], v[148:151], v[212:215]
    buffer_load_dwordx4 v[84:87], v33, s[32:35], s10 offen sc1
    s_waitcnt vmcnt(12)
    v_mfma_f32_16x16x32_bf16 v[216:219], a[80:83], v[152:155], v[216:219]
    v_mfma_f32_16x16x32_bf16 v[220:223], a[84:87], v[152:155], v[220:223]
    v_mfma_f32_16x16x32_bf16 v[224:227], a[88:91], v[152:155], v[224:227]
    v_mfma_f32_16x16x32_bf16 v[228:231], a[92:95], v[152:155], v[228:231]
    v_mfma_f32_16x16x32_bf16 v[232:235], a[96:99], v[152:155], v[232:235]
    buffer_load_dwordx4 v[88:91], v34, s[32:35], s10 offen sc1
    s_waitcnt vmcnt(12)
    v_mfma_f32_16x16x32_bf16 v[236:239], a[80:83], v[156:159], v[236:239]
    v_mfma_f32_16x16x32_bf16 v[240:243], a[84:87], v[156:159], v[240:243]
    v_mfma_f32_16x16x32_bf16 v[244:247], a[88:91], v[156:159], v[244:247]
    v_mfma_f32_16x16x32_bf16 v[248:251], a[92:95], v[156:159], v[248:251]
    v_mfma_f32_16x16x32_bf16 v[252:255], a[96:99], v[156:159], v[252:255]
    buffer_load_dwordx4 v[92:95], v35, s[32:35], s10 offen sc1
    s_mul_i32 s46, s13, 5
    buffer_load_dwordx4 a[180:183], v30, s[32:35], s46 offen offset:0 sc1
    s_add_u32 s1, s1, 16
    s_load_dwordx4 s[16:19], s[32:33], s1 glc
    buffer_load_dwordx4 a[184:187], v30, s[32:35], s46 offen offset:1024 sc1
    buffer_load_dwordx4 a[188:191], v30, s[32:35], s46 offen offset:2048 sc1
    buffer_load_dwordx4 a[192:195], v30, s[32:35], s46 offen offset:3072 sc1
    buffer_load_dwordx4 a[196:199], v31, s[32:35], s46 offen sc1
    s_waitcnt vmcnt(12)
    v_mfma_f32_16x16x32_bf16 v[176:179], a[100:103], v[160:163], v[176:179]
    v_mfma_f32_16x16x32_bf16 v[180:183], a[104:107], v[160:163], v[180:183]
    v_mfma_f32_16x16x32_bf16 v[184:187], a[108:111], v[160:163], v[184:187]
    v_mfma_f32_16x16x32_bf16 v[188:191], a[112:115], v[160:163], v[188:191]
    v_mfma_f32_16x16x32_bf16 v[192:195], a[116:119], v[160:163], v[192:195]
    buffer_load_dwordx4 v[96:99], v32, s[32:35], s11 offen sc1
    s_waitcnt vmcnt(12)
    v_mfma_f32_16x16x32_bf16 v[196:199], a[100:103], v[164:167], v[196:199]
    v_mfma_f32_16x16x32_bf16 v[200:203], a[104:107], v[164:167], v[200:203]
    v_mfma_f32_16x16x32_bf16 v[204:207], a[108:111], v[164:167], v[204:207]
    v_mfma_f32_16x16x32_bf16 v[208:211], a[112:115], v[164:167], v[208:211]
    v_mfma_f32_16x16x32_bf16 v[212:215], a[116:119], v[164:167], v[212:215]
    buffer_load_dwordx4 v[100:103], v33, s[32:35], s11 offen sc1
    s_waitcnt vmcnt(12)
    v_mfma_f32_16x16x32_bf16 v[216:219], a[100:103], v[168:171], v[216:219]
    v_mfma_f32_16x16x32_bf16 v[220:223], a[104:107], v[168:171], v[220:223]
    v_mfma_f32_16x16x32_bf16 v[224:227], a[108:111], v[168:171], v[224:227]
    v_mfma_f32_16x16x32_bf16 v[228:231], a[112:115], v[168:171], v[228:231]
    v_mfma_f32_16x16x32_bf16 v[232:235], a[116:119], v[168:171], v[232:235]
    buffer_load_dwordx4 v[104:107], v34, s[32:35], s11 offen sc1
    s_waitcnt vmcnt(12)
    v_mfma_f32_16x16x32_bf16 v[236:239], a[100:103], v[172:175], v[236:239]
    v_mfma_f32_16x16x32_bf16 v[240:243], a[104:107], v[172:175], v[240:243]
    v_mfma_f32_16x16x32_bf16 v[244:247], a[108:111], v[172:175], v[244:247]
    v_mfma_f32_16x16x32_bf16 v[248:251], a[112:115], v[172:175], v[248:251]
    v_mfma_f32_16x16x32_bf16 v[252:255], a[116:119], v[172:175], v[252:255]
    buffer_load_dwordx4 v[108:111], v35, s[32:35], s11 offen sc1
    s_waitcnt vmcnt(12)
    v_mfma_f32_16x16x32_bf16 v[176:179], a[120:123], v[80:83], v[176:179]
    v_mfma_f32_16x16x32_bf16 v[180:183], a[124:127], v[80:83], v[180:183]
    v_mfma_f32_16x16x32_bf16 v[184:187], a[128:131], v[80:83], v[184:187]
    v_mfma_f32_16x16x32_bf16 v[188:191], a[132:135], v[80:83], v[188:191]
    v_mfma_f32_16x16x32_bf16 v[192:195], a[136:139], v[80:83], v[192:195]
    s_waitcnt lgkmcnt(0)
    s_mov_b32 s55, 0
Lph2:
    s_xor_b64 s[16:17], s[16:17], s[70:71]
    s_xor_b64 s[18:19], s[18:19], s[70:71]
    s_or_b64 s[16:17], s[16:17], s[18:19]
    s_cmp_eq_u64 s[16:17], 0
    s_cbranch_scc1 Lph2_ok
    s_sleep 4
    s_load_dwordx4 s[16:19], s[32:33], s1 glc
    s_waitcnt lgkmcnt(0)
    s_add_u32 s55, s55, 1
    s_cmp_lt_u32 s55, 400000
    s_cbranch_scc1 Lph2
Lph2_ok:
    buffer_load_dwordx4 v[112:115], v32, s[32:35], s12 offen sc1
    s_waitcnt vmcnt(12)
    v_mfma_f32_16x16x32_bf16 v[196:199], a[120:123], v[84:87], v[196:199]
    v_mfma_f32_16x16x32_bf16 v[200:203], a[124:127], v[84:87], v[200:203]
    v_mfma_f32_16x16x32_bf16 v[204:207], a[128:131], v[84:87], v[204:207]
    v_mfma_f32_16x16x32_bf16 v[208:211], a[132:135], v[84:87], v[208:211]
    v_mfma_f32_16x16x32_bf16 v[212:215], a[136:139], v[84:87], v[212:215]
    buffer_load_dwordx4 v[116:119], v33, s[32:35], s12 offen sc1
    s_waitcnt vmcnt(12)
    v_mfma_f32_16x16x32_bf16 v[216:219], a[120:123], v[88:91], v[216:219]
    v_mfma_f32_16x16x32_bf16 v[220:223], a[124:127], v[88:91], v[220:223]
    v_mfma_f32_16x16x32_bf16 v[224:227], a[128:131], v[88:91], v[224:227]
    v_mfma_f32_16x16x32_bf16 v[228:231], a[132:135], v[88:91], v[228:231]
    v_mfma_f32_16x16x32_bf16 v[232:235], a[136:139], v[88:91], v[232:235]
    buffer_load_dwordx4 v[120:123], v34, s[32:35], s12 offen sc1
    s_waitcnt vmcnt(12)
    v_mfma_f32_16x16x32_bf16 v[236:239], a[120:123], v[92:95], v[236:239]
    v_mfma_f32_16x16x32_bf16 v[240:243], a[124:127], v[92:95], v[240:243]
    v_mfma_f32_16x16x32_bf16 v[244:247], a[128:131], v[92:95], v[244:247]
    v_mfma_f32_16x16x32_bf16 v[248:251], a[132:135], v[92:95], v[248:251]
    v_mfma_f32_16x16x32_bf16 v[252:255], a[136:139], v[92:95], v[252:255]
    s_mul_i32 s46, s14, 5
    buffer_load_dwordx4 a[200:203], v30, s[32:35], s46 offen offset:0 sc1
    buffer_load_dwordx4 a[204:207], v30, s[32:35], s46 offen offset:1024 sc1
    buffer_load_dwordx4 a[208:211], v30, s[32:35], s46 offen offset:2048 sc1
    buffer_load_dwordx4 a[212:215], v30, s[32:35], s46 offen offset:3072 sc1
    buffer_load_dwordx4 a[216:219], v31, s[32:35], s46 offen sc1
    buffer_load_dwordx4 v[124:127], v32, s[32:35], s13 offen sc1
    s_waitcnt vmcnt(12)
    v_mfma_f32_16x16x32_bf16 v[176:179], a[140:143], v[96:99], v[176:179]
    v_mfma_f32_16x16x32_bf16 v[180:183], a[144:147], v[96:99], v[180:183]
    v_mfma_f32_16x16x32_bf16 v[184:187], a[148:151], v[96:99], v[184:187]
    v_mfma_f32_16x16x32_bf16 v[188:191], a[152:155], v[96:99], v[188:191]
    v_mfma_f32_16x16x32_bf16 v[192:195], a[156:159], v[96:99], v[192:195]
    buffer_load_dwordx4 v[128:131], v33, s[32:35], s13 offen sc1
    s_waitcnt vmcnt(12)
    v_mfma_f32_16x16x32_bf16 v[196:199], a[140:143], v[100:103], v[196:199]
    v_mfma_f32_16x16x32_bf16 v[200:203], a[144:147], v[100:103], v[200:203]
    v_mfma_f32_16x16x32_bf16 v[204:207], a[148:151], v[100:103], v[204:207]
    v_mfma_f32_16x16x32_bf16 v[208:211], a[152:155], v[100:103], v[208:211]
    v_mfma_f32_16x16x32_bf16 v[212:215], a[156:159], v[100:103], v[212:215]
    buffer_load_dwordx4 v[132:135], v34, s[32:35], s13 offen sc1
    s_waitcnt vmcnt(12)
    v_mfma_f32_16x16x32_bf16 v[216:219], a[140:143], v[104:107], v[216:219]
    v_mfma_f32_16x16x32_bf16 v[220:223], a[144:147], v[104:107], v[220:223]
    v_mfma_f32_16x16x32_bf16 v[224:227], a[148:151], v[104:107], v[224:227]
    v_mfma_f32_16x16x32_bf16 v[228:231], a[152:155], v[104:107], v[228:231]
    v_mfma_f32_16x16x32_bf16 v[232:235], a[156:159], v[104:107], v[232:235]
    buffer_load_dwordx4 v[136:139], v32, s[32:35], s14 offen sc1
    s_waitcnt vmcnt(12)
    v_mfma_f32_16x16x32_bf16 v[236:239], a[140:143], v[108:111], v[236:239]
    v_mfma_f32_16x16x32_bf16 v[240:243], a[144:147], v[108:111], v[240:243]
    v_mfma_f32_16x16x32_bf16 v[244:247], a[148:151], v[108:111], v[244:247]
    v_mfma_f32_16x16x32_bf16 v[248:251], a[152:155], v[108:111], v[248:251]
    v_mfma_f32_16x16x32_bf16 v[252:255], a[156:159], v[108:111], v[252:255]
    buffer_load_dwordx4 v[140:143], v33, s[32:35], s14 offen sc1
    s_waitcnt vmcnt(12)
    v_mfma_f32_16x16x32_bf16 v[176:179], a[160:163], v[112:115], v[176:179]
    v_mfma_f32_16x16x32_bf16 v[180:183], a[164:167], v[112:115], v[180:183]
    v_mfma_f32_16x16x32_bf16 v[184:187], a[168:171], v[112:115], v[184:187]
    v_mfma_f32_16x16x32_bf16 v[188:191], a[172:175], v[112:115], v[188:191]
    v_mfma_f32_16x16x32_bf16 v[192:195], a[176:179], v[112:115], v[192:195]
    buffer_load_dwordx4 v[144:147], v34, s[32:35], s14 offen sc1
    s_waitcnt vmcnt(12)
    v_mfma_f32_16x16x32_bf16 v[196:199], a[160:163], v[116:119], v[196:199]
    v_mfma_f32_16x16x32_bf16 v[200:203], a[164:167], v[116:119], v[200:203]
    v_mfma_f32_16x16x32_bf16 v[204:207], a[168:171], v[116:119], v[204:207]
    v_mfma_f32_16x16x32_bf16 v[208:211], a[172:175], v[116:119], v[208:211]
    v_mfma_f32_16x16x32_bf16 v[212:215], a[176:179], v[116:119], v[212:215]
    s_mul_i32 s46, s15, 5
    buffer_load_dwordx4 a[220:223], v30, s[32:35], s46 offen offset:0 sc1
    s_waitcnt vmcnt(12)
    v_mfma_f32_16x16x32_bf16 v[216:219], a[160:163], v[120:123], v[216:219]
    v_mfma_f32_16x16x32_bf16 v[220:223], a[164:167], v[120:123], v[220:223]
    v_mfma_f32_16x16x32_bf16 v[224:227], a[168:171], v[120:123], v[224:227]
    v_mfma_f32_16x16x32_bf16 v[228:231], a[172:175], v[120:123], v[228:231]
    v_mfma_f32_16x16x32_bf16 v[232:235], a[176:179], v[120:123], v[232:235]
    buffer_load_dwordx4 a[224:227], v30, s[32:35], s46 offen offset:1024 sc1
    buffer_load_dwordx4 a[228:231], v30, s[32:35], s46 offen offset:2048 sc1
    buffer_load_dwordx4 a[232:235], v30, s[32:35], s46 offen offset:3072 sc1
    buffer_load_dwordx4 a[236:239], v31, s[32:35], s46 offen sc1
    buffer_load_dwordx4 v[148:151], v32, s[32:35], s15 offen sc1
    buffer_load_dwordx4 v[152:155], v33, s[32:35], s15 offen sc1
    s_waitcnt vmcnt(12)
    v_mfma_f32_16x16x32_bf16 v[176:179], a[180:183], v[124:127], v[176:179]
    v_mfma_f32_16x16x32_bf16 v[180:183], a[184:187], v[124:127], v[180:183]
    v_mfma_f32_16x16x32_bf16 v[184:187], a[188:191], v[124:127], v[184:187]
    v_mfma_f32_16x16x32_bf16 v[188:191], a[192:195], v[124:127], v[188:191]
    v_mfma_f32_16x16x32_bf16 v[192:195], a[196:199], v[124:127], v[192:195]
    buffer_load_dwordx4 v[156:159], v34, s[32:35], s15 offen sc1
    s_waitcnt vmcnt(12)
    v_mfma_f32_16x16x32_bf16 v[196:199], a[180:183], v[128:131], v[196:199]
    v_mfma_f32_16x16x32_bf16 v[200:203], a[184:187], v[128:131], v[200:203]
    v_mfma_f32_16x16x32_bf16 v[204:207], a[188:191], v[128:131], v[204:207]
    v_mfma_f32_16x16x32_bf16 v[208:211], a[192:195], v[128:131], v[208:211]
    v_mfma_f32_16x16x32_bf16 v[212:215], a[196:199], v[128:131], v[212:215]
    buffer_load_dwordx4 v[160:163], v35, s[32:35], s12 offen sc1
    s_waitcnt vmcnt(12)
    v_mfma_f32_16x16x32_bf16 v[216:219], a[180:183], v[132:135], v[216:219]
    v_mfma_f32_16x16x32_bf16 v[220:223], a[184:187], v[132:135], v[220:223]
    v_mfma_f32_16x16x32_bf16 v[224:227], a[188:191], v[132:135], v[224:227]
    v_mfma_f32_16x16x32_bf16 v[228:231], a[192:195], v[132:135], v[228:231]
    v_mfma_f32_16x16x32_bf16 v[232:235], a[196:199], v[132:135], v[232:235]
    buffer_load_dwordx4 v[164:167], v35, s[32:35], s13 offen sc1
    s_waitcnt vmcnt(12)
    v_mfma_f32_16x16x32_bf16 v[176:179], a[200:203], v[136:139], v[176:179]
    v_mfma_f32_16x16x32_bf16 v[180:183], a[204:207], v[136:139], v[180:183]
    v_mfma_f32_16x16x32_bf16 v[184:187], a[208:211], v[136:139], v[184:187]
    v_mfma_f32_16x16x32_bf16 v[188:191], a[212:215], v[136:139], v[188:191]
    v_mfma_f32_16x16x32_bf16 v[192:195], a[216:219], v[136:139], v[192:195]
    buffer_load_dwordx4 v[168:171], v35, s[32:35], s14 offen sc1
    s_waitcnt vmcnt(12)
    v_mfma_f32_16x16x32_bf16 v[196:199], a[200:203], v[140:143], v[196:199]
    v_mfma_f32_16x16x32_bf16 v[200:203], a[204:207], v[140:143], v[200:203]
    v_mfma_f32_16x16x32_bf16 v[204:207], a[208:211], v[140:143], v[204:207]
    v_mfma_f32_16x16x32_bf16 v[208:211], a[212:215], v[140:143], v[208:211]
    v_mfma_f32_16x16x32_bf16 v[212:215], a[216:219], v[140:143], v[212:215]
    buffer_load_dwordx4 v[172:175], v35, s[32:35], s15 offen sc1
    s_waitcnt vmcnt(12)
    v_mfma_f32_16x16x32_bf16 v[216:219], a[200:203], v[144:147], v[216:219]
    v_mfma_f32_16x16x32_bf16 v[220:223], a[204:207], v[144:147], v[220:223]
    v_mfma_f32_16x16x32_bf16 v[224:227], a[208:211], v[144:147], v[224:227]
    v_mfma_f32_16x16x32_bf16 v[228:231], a[212:215], v[144:147], v[228:231]
    v_mfma_f32_16x16x32_bf16 v[232:235], a[216:219], v[144:147], v[232:235]
    s_waitcnt vmcnt(6)
    v_mfma_f32_16x16x32_bf16 v[176:179], a[220:223], v[148:151], v[176:179]
    v_mfma_f32_16x16x32_bf16 v[180:183], a[224:227], v[148:151], v[180:183]
    v_mfma_f32_16x16x32_bf16 v[184:187], a[228:231], v[148:151], v[184:187]
    v_mfma_f32_16x16x32_bf16 v[188:191], a[232:235], v[148:151], v[188:191]
    v_mfma_f32_16x16x32_bf16 v[192:195], a[236:239], v[148:151], v[192:195]
    s_waitcnt vmcnt(5)
    v_mfma_f32_16x16x32_bf16 v[196:199], a[220:223], v[152:155], v[196:199]
    v_mfma_f32_16x16x32_bf16 v[200:203], a[224:227], v[152:155], v[200:203]
    v_mfma_f32_16x16x32_bf16 v[204:207], a[228:231], v[152:155], v[204:207]
    v_mfma_f32_16x16x32_bf16 v[208:211], a[232:235], v[152:155], v[208:211]
    ds_write_b128 v25, v[176:179] offset:0
    v_mfma_f32_16x16x32_bf16 v[212:215], a[236:239], v[152:155], v[212:215]
    ds_write_b128 v25, v[180:183] offset:1024
    ds_write_b128 v25, v[184:187] offset:2048
    ds_write_b128 v25, v[188:191] offset:3072
    ds_write_b128 v25, v[192:195] offset:4096
    s_waitcnt vmcnt(4)
    v_mfma_f32_16x16x32_bf16 v[216:219], a[220:223], v[156:159], v[216:219]
    v_mfma_f32_16x16x32_bf16 v[220:223], a[224:227], v[156:159], v[220:223]
    v_mfma_f32_16x16x32_bf16 v[224:227], a[228:231], v[156:159], v[224:227]
    v_mfma_f32_16x16x32_bf16 v[228:231], a[232:235], v[156:159], v[228:231]
    ds_write_b128 v26, v[196:199] offset:0
    v_mfma_f32_16x16x32_bf16 v[232:235], a[236:239], v[156:159], v[232:235]
    ds_write_b128 v26, v[200:203] offset:1024
    ds_write_b128 v26, v[204:207] offset:2048
    ds_write_b128 v26, v[208:211] offset:3072
    ds_write_b128 v26, v[212:215] offset:4096
    s_waitcnt vmcnt(3)
    v_mfma_f32_16x16x32_bf16 v[236:239], a[160:163], v[160:163], v[236:239]
    v_mfma_f32_16x16x32_bf16 v[240:243], a[164:167], v[160:163], v[240:243]
    v_mfma_f32_16x16x32_bf16 v[244:247], a[168:171], v[160:163], v[244:247]
    v_mfma_f32_16x16x32_bf16 v[248:251], a[172:175], v[160:163], v[248:251]
    ds_write_b128 v27, v[216:219] offset:0
    v_mfma_f32_16x16x32_bf16 v[252:255], a[176:179], v[160:163], v[252:255]
    ds_write_b128 v27, v[220:223] offset:1024
    ds_write_b128 v27, v[224:227] offset:2048
    ds_write_b128 v27, v[228:231] offset:3072
    ds_write_b128 v27, v[232:235] offset:4096
    s_waitcnt vmcnt(2)
    v_mfma_f32_16x16x32_bf16 v[236:239], a[180:183], v[164:167], v[236:239]
    v_mfma_f32_16x16x32_bf16 v[240:243], a[184:187], v[164:167], v[240:243]
    v_mfma_f32_16x16x32_bf16 v[244:247], a[188:191], v[164:167], v[244:247]
    v_mfma_f32_16x16x32_bf16 v[248:251], a[192:195], v[164:167], v[248:251]
    s_waitcnt lgkmcnt(0)
    s_barrier
    ds_read_b128 v[176:179], v28 offset:0
    ds_read_b128 v[180:183], v28 offset:1024
    ds_read_b128 v[184:187], v28 offset:2048
    ds_read_b128 v[188:191], v28 offset:3072
    ds_read_b128 v[192:195], v28 offset:4096
    ds_read_b128 v[196:199], v28 offset:5120
    ds_read_b128 v[200:203], v28 offset:6144
    v_mfma_f32_16x16x32_bf16 v[252:255], a[196:199], v[164:167], v[252:255]
    ds_read_b128 v[204:207], v28 offset:7168
    ds_read_b128 v[208:211], v28 offset:8192
    ds_read_b128 v[212:215], v28 offset:9216
    ds_read_b128 v[216:219], v28 offset:10240
    ds_read_b128 v[220:223], v28 offset:11264
    ds_read_b128 v[224:227], v28 offset:12288
    ds_read_b128 v[228:231], v28 offset:13312
    ds_read_b128 v[232:235], v28 offset:14336
    s_waitcnt vmcnt(1)
    v_mfma_f32_16x16x32_bf16 v[236:239], a[200:203], v[168:171], v[236:239]
    v_mfma_f32_16x16x32_bf16 v[240:243], a[204:207], v[168:171], v[240:243]
    s_waitcnt lgkmcnt(5)
    v_add_f32 v176, v176, v196
    v_add_f32 v177, v177, v197
    v_add_f32 v178, v178, v198
    v_add_f32 v179, v179, v199
    v_add_f32 v180, v180, v200
    v_mfma_f32_16x16x32_bf16 v[244:247], a[208:211], v[168:171], v[244:247]
    v_add_f32 v181, v181, v201
    v_add_f32 v182, v182, v202
    v_add_f32 v183, v183, v203
    v_add_f32 v184, v184, v204
    v_add_f32 v185, v185, v205
    v_mfma_f32_16x16x32_bf16 v[248:251], a[212:215], v[168:171], v[248:251]
    v_add_f32 v186, v186, v206
    v_add_f32 v187, v187, v207
    v_add_f32 v188, v188, v208
    v_add_f32 v189, v189, v209
    v_add_f32 v190, v190, v210
    v_mfma_f32_16x16x32_bf16 v[252:255], a[216:219], v[168:171], v[252:255]
    v_add_f32 v191, v191, v211
    v_add_f32 v192, v192, v212
    v_add_f32 v193, v193, v213
    v_add_f32 v194, v194, v214
    v_add_f32 v195, v195, v215
    s_waitcnt vmcnt(0)
    v_mfma_f32_16x16x32_bf16 v[236:239], a[220:223], v[172:175], v[236:239]
    s_waitcnt lgkmcnt(0)
    v_add_f32 v176, v176, v216
    v_add_f32 v177, v177, v217
    v_add_f32 v178, v178, v218
    v_add_f32 v179, v179, v219
    v_mfma_f32_16x16x32_bf16 v[240:243], a[224:227], v[172:175], v[240:243]
    v_add_f32 v180, v180, v220
    v_add_f32 v181, v181, v221
    v_add_f32 v182, v182, v222
    v_add_f32 v183, v183, v223
    v_mfma_f32_16x16x32_bf16 v[244:247], a[228:231], v[172:175], v[244:247]
    v_add_f32 v184, v184, v224
    v_add_f32 v185, v185, v225
    v_add_f32 v186, v186, v226
    v_add_f32 v187, v187, v227
    v_mfma_f32_16x16x32_bf16 v[248:251], a[232:235], v[172:175], v[248:251]
    v_add_f32 v188, v188, v228
    v_add_f32 v189, v189, v229
    v_add_f32 v190, v190, v230
    v_add_f32 v191, v191, v231
    v_mfma_f32_16x16x32_bf16 v[252:255], a[236:239], v[172:175], v[252:255]
    v_add_f32 v192, v192, v232
    v_add_f32 v193, v193, v233
    v_add_f32 v194, v194, v234
    v_add_f32 v195, v195, v235
    s_waitcnt lgkmcnt(0)
    s_nop 3
    v_pk_add_f32 v[176:177], v[176:177], v[236:237]
    v_pk_add_f32 v[178:179], v[178:179], v[238:239]
    v_cvt_pk_bf16_f32 v196, v176, v177
    v_cvt_pk_bf16_f32 v197, v178, v179
    ds_write_b64 v20, v[196:197] offset:0
    v_pk_add_f32 v[180:181], v[180:181], v[240:241]
    v_pk_add_f32 v[182:183], v[182:183], v[242:243]
    v_cvt_pk_bf16_f32 v198, v180, v181
    v_cvt_pk_bf16_f32 v199, v182, v183
    ds_write_b64 v20, v[198:199] offset:32
    v_pk_add_f32 v[184:185], v[184:185], v[244:245]
    v_pk_add_f32 v[186:187], v[186:187], v[246:247]
    v_cvt_pk_bf16_f32 v200, v184, v185
    v_cvt_pk_bf16_f32 v201, v186, v187
    ds_write_b64 v20, v[200:201] offset:64
    v_pk_add_f32 v[188:189], v[188:189], v[248:249]
    v_pk_add_f32 v[190:191], v[190:191], v[250:251]
    v_cvt_pk_bf16_f32 v202, v188, v189
    v_cvt_pk_bf16_f32 v203, v190, v191
    ds_write_b64 v20, v[202:203] offset:96
    v_pk_add_f32 v[192:193], v[192:193], v[252:253]
    v_pk_add_f32 v[194:195], v[194:195], v[254:255]
    v_cvt_pk_bf16_f32 v204, v192, v193
    v_cvt_pk_bf16_f32 v205, v194, v195
    ds_write_b64 v20, v[204:205] offset:128
    s_waitcnt lgkmcnt(0)
    ds_read_b128 v[216:219], v42
    ds_read_b128 v[220:223], v43
    ds_read_b128 v[224:227], v44
    s_waitcnt lgkmcnt(2)
    buffer_store_dwordx4 v[216:219], v38, s[40:43], s59 offen
    s_waitcnt lgkmcnt(1)
    buffer_store_dwordx4 v[220:223], v39, s[40:43], s59 offen
    s_waitcnt lgkmcnt(0)
    s_mov_b32 exec_hi, 0
    buffer_store_dwordx4 v[224:227], v40, s[40:43], s59 offen
Lend:
    s_endpgm
.section .rodata,"a"
.p2align 6
.amdhsa_kernel standalone__dense_activation_relu__prompt_kernel
  .amdhsa_next_free_vgpr 512
  .amdhsa_next_free_sgpr 102
  .amdhsa_accum_offset 256
  .amdhsa_group_segment_fixed_size 0
  .amdhsa_kernarg_size 48
  .amdhsa_user_sgpr_count 2
  .amdhsa_user_sgpr_kernarg_segment_ptr 1
  .amdhsa_system_sgpr_workgroup_id_x 1
.end_amdhsa_kernel
```
